```python
import torch

def _softmax(x, axis=-1):
    return torch.softmax(x, dim=axis)
def _gelu(x):
    return torch.nn.functional.gelu(x, approximate="tanh")
def _silu(x):
    return torch.nn.functional.silu(x)
def _sigmoid(x):
    return torch.sigmoid(x)
def _layernorm(x, axis=-1, eps=1e-5):
    m = x.mean(dim=axis, keepdim=True)
    v = x.var(dim=axis, keepdim=True, unbiased=False)
    return (x - m) / torch.sqrt(v + eps)
def _scatter_add(tgt, idx, src, axis=0):
    return tgt.clone().index_add_(axis, idx, src)
def _segment_sum(src, seg, n):
    out = torch.zeros((n,) + src.shape[1:], dtype=src.dtype)
    return out.index_add_(0, seg, src)
def _pad(x, pw):
    flat = tuple(v for pair in reversed(pw) for v in pair)
    return torch.nn.functional.pad(x, flat)

kernel_name = 'sequential_preLN__ssm_conv_s4d__dense_activation_silu__prompt'

def setup_inputs():

    _w = (lambda a: (lambda t: t.to(torch.bfloat16) if t.is_floating_point() else t)(torch.as_tensor(a)))
    def _A_setup():
        Bsz, L, D, N = 1, 2048, 512, 128
        return {
            "u": _w((lambda *s: torch.randn(*s, dtype=torch.bfloat16) * 0.05)(Bsz, L, D)),
            "log_A_real": _w((lambda *s: torch.randn(*s, dtype=torch.bfloat16) * 6.4)(D, N) * 0.5),
            "A_imag": _w((lambda *s: torch.randn(*s, dtype=torch.bfloat16) * 0.05)(D, N) * 3.14),
            "C_real": _w((lambda *s: torch.randn(*s, dtype=torch.bfloat16) * 0.05)(D, N) / N ** 0.5),
            "C_imag": _w((lambda *s: torch.randn(*s, dtype=torch.bfloat16) * 0.05)(D, N) / N ** 0.5),
            "log_dt": _w((lambda *s: torch.randn(*s, dtype=torch.bfloat16) * 0.05)(D) * 0.5 - 4.0),
            "D_skip": _w((lambda *s: torch.randn(*s, dtype=torch.bfloat16) * 0.05)(D)),
        }
    _A_in = _A_setup()

    def _B_setup():
        B, S, D, F = 1, 2048, 512, 1376
        return {
            "x": _w((lambda *s: torch.randn(*s, dtype=torch.bfloat16) * 0.05)(B, S, D)),
            "w1": _w((lambda *s: torch.randn(*s, dtype=torch.bfloat16) * 0.8)(D, F) * (D ** -0.5)),
            "w2": _w((lambda *s: torch.randn(*s, dtype=torch.bfloat16) * 0.2)(F, D) * (F ** -0.5)),
        }
    _B_in = _B_setup()

    return {
        "A_u": _A_in["u"],
        "A_log_A_real": _A_in["log_A_real"],
        "A_A_imag": _A_in["A_imag"],
        "A_C_real": _A_in["C_real"],
        "A_C_imag": _A_in["C_imag"],
        "A_log_dt": _A_in["log_dt"],
        "A_D_skip": _A_in["D_skip"],
        "B_x": _B_in["x"],
        "B_w1": _B_in["w1"],
        "B_w2": _B_in["w2"],
    }

def reference(A_u, A_log_A_real, A_A_imag, A_C_real, A_C_imag, A_log_dt, A_D_skip, B_x, B_w1, B_w2):
    def _A_ref(u, log_A_real, A_imag, C_real, C_imag, log_dt, D_skip):
        L = u.shape[1]
        dt = torch.exp(log_dt)
        A = -torch.exp(log_A_real) + 1j * A_imag
        C = (C_real + 1j * C_imag) * dt[:, None]
        pos = (lambda x, dt: x.to(dt))(torch.arange(L), log_dt.dtype)
        P = torch.exp((A * dt[:, None])[:, :, None] * pos[None, None, :])
        K = 2.0 * torch.einsum("dn,dnl->dl", C, P).real
        L2 = 2 * L
        u_t = (lambda x, *d: x.permute(*d))(u, 0, 2, 1)
        Kf = (lambda x, *a, **k: torch.fft.rfft(x.float(), *a, **k))(K, L2)
        Uf = (lambda x, *a, **k: torch.fft.rfft(x.float(), *a, **k))(u_t, L2)
        y = (lambda x, *a, **k: torch.fft.irfft(x, *a, **k).to(torch.bfloat16))(Uf * Kf[None, :, :], L2)[:, :, :L]
        y = (lambda x, *d: x.permute(*d))(y, 0, 2, 1)
        return y + u * D_skip[None, None, :]

    def _B_ref(x, w1, w2):
        h = torch.einsum("bsd,df->bsf", x, w1)
        h = _silu(h)
        out = torch.einsum("bsf,fd->bsd", h, w2)
        return out

    x = A_u
    h = x + _A_ref(_layernorm(x, axis=-1), A_log_A_real, A_A_imag, A_C_real, A_C_imag, A_log_dt, A_D_skip)
    h2 = h + _B_ref(_layernorm(h, axis=-1), B_w1, B_w2)
    return h2
```

```asm
; @launch grid=(256,1,1) block=(256,1,1) lds=146528
.amdgcn_target "amdgcn-amd-amdhsa--gfx950"
.text
.globl sequential_preLN__ssm_conv_s4d__dense_activation_silu__prompt_kernel
.p2align 12
.fill 832, 4, 0xbf810000
.p2align 8
.type sequential_preLN__ssm_conv_s4d__dense_activation_silu__prompt_kernel,@function
sequential_preLN__ssm_conv_s4d__dense_activation_silu__prompt_kernel:
    s_cmp_ge_u32 s2, 256
    s_cbranch_scc1 K_END
    s_load_dwordx16 s[4:19], s[0:1], 0
    s_load_dwordx8 s[20:27], s[0:1], 64
    s_load_dwordx2 s[28:29], s[0:1], 96
    v_and_b32 v1, 63, v0
    v_lshrrev_b32 v4, 6, v0
    s_nop 0
    v_readfirstlane_b32 s3, v4
    s_and_b32 s48, s2, 7
    s_lshr_b32 s49, s2, 3
    s_lshl_b32 s50, s48, 5
    s_add_u32 s50, s50, s49
    s_and_b32 s54, s3, 1
    s_lshr_b32 s51, s50, 3
    s_and_b32 s52, s50, 7
    s_lshl_b32 s60, s51, 16
    s_lshl_b32 s61, s52, 7
    s_add_u32 s60, s60, s61
    s_lshl_b32 s61, s3, 5
    s_add_u32 s60, s60, s61
    v_bfe_u32 v25, v1, 1, 3
    v_lshl_add_u32 v26, v25, 13, s60
    v_lshrrev_b32 v27, 4, v1
    v_lshl_add_u32 v26, v27, 10, v26
    v_and_b32 v25, 1, v1
    v_lshl_add_u32 v26, v25, 4, v26
    v_add_u32 v27, 3072, v26
    s_mul_i32 s62, s3, 17408
    s_mov_b32 m0, s62
    s_lshl_b32 s60, s50, 13
    s_lshl_b32 s61, s3, 11
    s_add_u32 s60, s60, s61
    v_lshl_add_u32 v28, v1, 4, s60
    s_getpc_b64 s[30:31]
PC1:
    s_lshl2_add_u32 s63, s49, s3
    s_lshl_b32 s63, s63, 6
    s_add_u32 s64, s63, 8192
    s_add_u32 s65, s63, 16384
    v_mov_b32 v16, 0
    s_lshl_b32 s60, s50, 2
    v_mov_b32 v17, s60
    s_lshl_b32 s60, s50, 13
    s_add_u32 s60, s60, 1052672
    v_lshl_add_u32 v22, v0, 4, s60
    v_mov_b64 v[108:109], -1
    v_mov_b64 v[110:111], -1
    s_lshl_b32 s60, s50, 9
    v_lshl_add_u32 v21, v0, 1, s60
    v_lshrrev_b32 v30, 1, v0
    v_and_or_b32 v30, v30, 64, v1
    v_min_u32 v30, 42, v30
    s_mul_i32 s60, s2, 5504
    v_lshl_add_u32 v23, v30, 7, s60
    s_waitcnt lgkmcnt(0)
    s_load_dword s80, s[30:31], s63
    s_load_dword s58, s[30:31], s64
    s_load_dword s59, s[30:31], s65
    global_load_lds_dwordx4 v26, s[4:5]
    global_load_lds_dwordx4 v27, s[4:5] offset:1024
    global_load_dwordx4 v[100:103], v28, s[4:5]
    global_load_dwordx4 v[104:107], v28, s[4:5] offset:1024
    global_load_dword v16, v16, s[28:29]
    s_cmp_eq_u32 s54, 1
    s_cselect_b64 s[78:79], s[22:23], s[20:21]
    s_mul_i32 s60, s49, 28
    s_mul_i32 s61, s3, 7
    s_add_u32 s60, s60, s61
    v_min_u32 v127, 6, v1
    global_store_dwordx4 v22, v[108:111], s[28:29] offset:-4096 sc1
    global_store_dwordx4 v22, v[108:111], s[28:29] sc1
    v_add_u32 v127, s60, v127
    global_load_ushort v138, v21, s[6:7]
    global_load_ushort v139, v21, s[8:9]
    global_load_dword v15, v17, s[14:15]
    global_load_ushort v140, v21, s[10:11]
    global_load_ushort v141, v21, s[12:13]
    global_load_dword v17, v17, s[16:17]
    v_lshrrev_b32 v18, 7, v127
    v_lshl_add_u32 v127, v18, 6, v127
    s_mul_i32 s60, s49, 15
    s_lshl_b32 s61, s3, 2
    v_min_u32 v129, 3, v1
    v_add_u32 v129, s61, v129
    v_min_u32 v129, 14, v129
    v_add_u32 v129, s60, v129
    v_lshrrev_b32 v18, 6, v129
    v_lshlrev_b32 v18, 7, v18
    v_min_u32 v18, 0x300, v18
    v_add_u32 v129, v18, v129
    v_add_u32 v129, 0x80, v129
    s_sub_u32 s60, 0x1ff, s22
    s_and_b32 s60, s60, 0x380
    v_lshl_add_u32 v127, v127, 10, s60
    v_lshl_add_u32 v129, v129, 10, s60
    s_mov_b64 s[76:77], s[22:23]
    v_and_b32 v25, 7, v1
    v_lshrrev_b32 v27, 3, v1
    v_lshl_add_u32 v20, v25, 5, s62
    v_lshl_add_u32 v20, v27, 2, v20
    s_lshl_b32 s60, s52, 5
    s_lshl_b32 s61, s3, 3
    s_add_u32 s60, s60, s61
    s_mul_i32 s60, s60, 12288
    s_mul_i32 s61, s51, 384
    s_add_u32 s60, s60, s61
    s_add_u32 s60, s60, 13631488
    v_mul_u32_u24 v27, 12288, v27
    v_lshl_add_u32 v27, v25, 4, v27
    v_add_u32 v219, s60, v27
    s_lshr_b32 s53, s3, 1
    s_getreg_b32 s81, hwreg(HW_REG_XCC_ID, 0, 3)
    s_add_u32 s40, s28, 1048576
    s_addc_u32 s41, s29, 0
    s_mov_b32 s42, 2097152
    s_mov_b32 s43, 0x20000
    s_add_u32 s44, s28, 4194304
    s_addc_u32 s45, s29, 0
    s_mov_b32 s46, 5767168
    global_load_ubyte v253, v23, s[78:79]
    s_mov_b32 s47, 0x20000
    s_cmp_eq_u32 s52, 7
    s_cselect_b32 s60, 6, s52
    s_mul_i32 s60, s60, 384
    s_lshl_b32 s61, s3, 6
    s_add_u32 s61, s61, s60
    s_lshl_b32 s62, s53, 6
    s_add_u32 s62, s62, s60
    s_add_u32 s62, s62, 256
    s_lshl1_add_u32 s63, s52, s53
    s_cmp_eq_u32 s63, 14
    s_cselect_b32 s62, 2688, s62
    s_mul_i32 s63, s54, 88064
    s_sub_u32 s64, 88064, s63
    s_add_u32 s65, s61, s63
    s_add_u32 s32, s20, s65
    s_addc_u32 s33, s21, 0
    s_add_u32 s65, s61, s64
    s_add_u32 s34, s20, s65
    s_addc_u32 s35, s21, 0
    s_add_u32 s65, s62, s63
    s_add_u32 s36, s20, s65
    s_addc_u32 s37, s21, 0
    s_lshl_b32 s60, s3, 15
    s_add_u32 s70, s22, s60
    s_addc_u32 s71, s23, 0
    s_mul_i32 s60, s53, 196608
    s_lshl_b32 s61, s54, 15
    s_add_u32 s60, s60, s61
    s_add_u32 s60, s60, 131072
    s_add_u32 s72, s22, s60
    s_addc_u32 s73, s23, 0
    s_add_u32 s60, s60, 1179648
    s_cmp_eq_u32 s53, 1
    s_cselect_b32 s60, 1376256, s60
    s_add_u32 s74, s22, s60
    s_addc_u32 s75, s23, 0
    v_and_b32 v250, 15, v1
    v_lshlrev_b32 v250, 2, v250
    v_lshrrev_b32 v249, 4, v1
    v_lshl_add_u32 v142, v249, 13, v250
    v_mul_u32_u24 v249, 22016, v249
    v_add3_u32 v248, v249, v250, 0
    v_add_u32 v248, 2752, v248
    v_add_u32 v249, 8256, v248
    v_add_u32 v250, 16512, v248
    s_lshl_b32 s60, s52, 7
    s_lshl_b32 s61, s53, 6
    s_add_u32 s60, s60, s61
    s_add_u32 s60, s60, 4096
    v_add_u32 v142, s60, v142
    v_xor_b32 v143, 64, v142
    s_mul_i32 s62, s53, 13136
    s_add_u32 s62, s62, 69664
    s_sub_u32 s63, s62, 138176
    v_and_b32 v32, 127, v0
    v_lshlrev_b32 v33, 3, v32
    v_sub_u32 v33, 2047, v33
    v_cvt_f32_u32 v33, v33
    v_mov_b32 v26, s63
    v_subrev_f32 v24, 0x00000000, v33
    v_subrev_f32 v25, 0x3f800000, v33
    v_cvt_pk_bf16_f32 v24, v24, v25
    v_pk_lshrrev_b16 v25, 4, v24 op_sel_hi:[0,1]
    v_pk_add_u16 v24, v24, v25
    v_mad_u32_u16 v64, v24, 8, v26
    v_mad_u32_u16 v65, v24, 8, v26 op_sel:[1,0,0,0]
    v_subrev_f32 v24, 0x40000000, v33
    v_subrev_f32 v25, 0x40400000, v33
    v_cvt_pk_bf16_f32 v24, v24, v25
    v_pk_lshrrev_b16 v25, 4, v24 op_sel_hi:[0,1]
    v_pk_add_u16 v24, v24, v25
    v_mad_u32_u16 v66, v24, 8, v26
    v_mad_u32_u16 v67, v24, 8, v26 op_sel:[1,0,0,0]
    v_subrev_f32 v24, 0x40800000, v33
    v_subrev_f32 v25, 0x40a00000, v33
    v_cvt_pk_bf16_f32 v24, v24, v25
    v_pk_lshrrev_b16 v25, 4, v24 op_sel_hi:[0,1]
    v_pk_add_u16 v24, v24, v25
    v_mad_u32_u16 v68, v24, 8, v26
    v_mad_u32_u16 v69, v24, 8, v26 op_sel:[1,0,0,0]
    v_subrev_f32 v24, 0x40c00000, v33
    v_subrev_f32 v25, 0x40e00000, v33
    v_cvt_pk_bf16_f32 v24, v24, v25
    v_pk_lshrrev_b16 v25, 4, v24 op_sel_hi:[0,1]
    v_pk_add_u16 v24, v24, v25
    v_mad_u32_u16 v70, v24, 8, v26
    v_mad_u32_u16 v71, v24, 8, v26 op_sel:[1,0,0,0]
    v_subrev_f32 v24, 0x41000000, v33
    v_subrev_f32 v25, 0x41100000, v33
    v_cvt_pk_bf16_f32 v24, v24, v25
    v_pk_lshrrev_b16 v25, 4, v24 op_sel_hi:[0,1]
    v_pk_add_u16 v24, v24, v25
    v_mad_u32_u16 v72, v24, 8, v26
    v_mad_u32_u16 v73, v24, 8, v26 op_sel:[1,0,0,0]
    v_subrev_f32 v24, 0x41200000, v33
    v_subrev_f32 v25, 0x41300000, v33
    v_cvt_pk_bf16_f32 v24, v24, v25
    v_pk_lshrrev_b16 v25, 4, v24 op_sel_hi:[0,1]
    v_pk_add_u16 v24, v24, v25
    v_mad_u32_u16 v74, v24, 8, v26
    v_subrev_f32 v24, 0x44800000, v33
    v_subrev_f32 v25, 0x44802000, v33
    v_cvt_pk_bf16_f32 v24, v24, v25
    v_pk_lshrrev_b16 v25, 4, v24 op_sel_hi:[0,1]
    v_pk_add_u16 v24, v24, v25
    v_mad_u32_u16 v75, v24, 8, v26
    v_mad_u32_u16 v76, v24, 8, v26 op_sel:[1,0,0,0]
    v_subrev_f32 v24, 0x44804000, v33
    v_subrev_f32 v25, 0x44806000, v33
    v_cvt_pk_bf16_f32 v24, v24, v25
    v_pk_lshrrev_b16 v25, 4, v24 op_sel_hi:[0,1]
    v_pk_add_u16 v24, v24, v25
    v_mad_u32_u16 v77, v24, 8, v26
    v_mad_u32_u16 v78, v24, 8, v26 op_sel:[1,0,0,0]
    v_subrev_f32 v24, 0x44808000, v33
    v_subrev_f32 v25, 0x4480a000, v33
    v_cvt_pk_bf16_f32 v24, v24, v25
    v_pk_lshrrev_b16 v25, 4, v24 op_sel_hi:[0,1]
    v_pk_add_u16 v24, v24, v25
    v_mad_u32_u16 v79, v24, 8, v26
    v_mad_u32_u16 v80, v24, 8, v26 op_sel:[1,0,0,0]
    v_subrev_f32 v24, 0x4480c000, v33
    v_subrev_f32 v25, 0x4480e000, v33
    v_cvt_pk_bf16_f32 v24, v24, v25
    v_pk_lshrrev_b16 v25, 4, v24 op_sel_hi:[0,1]
    v_pk_add_u16 v24, v24, v25
    v_mad_u32_u16 v81, v24, 8, v26
    v_mad_u32_u16 v82, v24, 8, v26 op_sel:[1,0,0,0]
    v_subrev_f32 v24, 0x44810000, v33
    v_subrev_f32 v25, 0x44812000, v33
    v_cvt_pk_bf16_f32 v24, v24, v25
    v_pk_lshrrev_b16 v25, 4, v24 op_sel_hi:[0,1]
    v_pk_add_u16 v24, v24, v25
    v_mad_u32_u16 v83, v24, 8, v26
    v_mad_u32_u16 v84, v24, 8, v26 op_sel:[1,0,0,0]
    v_subrev_f32 v24, 0x44814000, v33
    v_subrev_f32 v25, 0x44816000, v33
    v_cvt_pk_bf16_f32 v24, v24, v25
    v_pk_lshrrev_b16 v25, 4, v24 op_sel_hi:[0,1]
    v_pk_add_u16 v24, v24, v25
    v_mad_u32_u16 v85, v24, 8, v26
    v_cmp_eq_u32 vcc, 127, v32
    s_sub_u32 s60, s62, 8
    s_sub_u32 s61, s62, 32
    v_mov_b32 v24, s60
    v_mov_b32 v25, s61
    v_cndmask_b32 v82, v82, v24, vcc
    v_cndmask_b32 v83, v83, v25, vcc
    v_cndmask_b32 v84, v84, v25, vcc
    v_cndmask_b32 v85, v85, v25, vcc
    s_lshl_b32 s64, s54, 2
    v_add_u32 v26, s64, v26
HOP_C:
    v_add_u32 v24, s64, v24
    s_add_u32 s64, s64, s62
    v_and_b32 v27, 15, v1
    v_lshrrev_b32 v28, 4, v1
    v_lshlrev_b32 v29, 4, v27
    v_lshl_add_u32 v29, v28, 2, v29
    v_cvt_f32_u32 v29, v29
    v_add_f32 v30, 1.0, v29
    v_cvt_pk_bf16_f32 v30, v29, v30
    v_pk_lshrrev_b16 v31, 4, v30 op_sel_hi:[0,1]
    v_pk_add_u16 v30, v30, v31
    v_mad_u32_u16 v86, v30, 8, v26
    v_mad_u32_u16 v87, v30, 8, v26 op_sel:[1,0,0,0]
    v_add_f32 v30, 2.0, v29
    v_add_f32 v31, 1.0, v30
    v_cvt_pk_bf16_f32 v30, v30, v31
    v_pk_lshrrev_b16 v31, 4, v30 op_sel_hi:[0,1]
    v_pk_add_u16 v30, v30, v31
    v_mad_u32_u16 v88, v30, 8, v26
    v_mad_u32_u16 v89, v30, 8, v26 op_sel:[1,0,0,0]
    v_cmp_eq_u32 vcc, 0, v1
    s_nop 1
    v_cndmask_b32 v86, v86, v24, vcc
    v_lshlrev_b32 v30, 6, v28
    v_lshl_add_u32 v31, v27, 1, v30
    v_add_u32 v31, 0x500, v31
    v_lshl_add_u32 v30, v27, 2, v30
    v_add_u32 v30, 0x400, v30
    v_lshlrev_b32 v34, 2, v28
    v_lshl_add_u32 v34, v27, 3, v34
    v_add_u32 v34, 0x400, v34
    v_cmp_gt_u32 vcc, 2, v28
    s_nop 1
    v_cndmask_b32 v30, v30, v34, vcc
    v_lshl_or_b32 v30, v31, 16, v30
    v_mov_b32 v34, s64
    v_pk_lshrrev_b16 v31, 4, v30 op_sel_hi:[0,1]
    v_pk_add_u16 v30, v30, v31
    v_mad_u32_u16 v90, v30, 8, v34
    v_mad_u32_u16 v91, v30, 8, v34 op_sel:[1,0,0,0]
    s_mul_i32 s60, s3, 17408
    v_mul_u32_u24 v30, 272, v27
    v_lshl_add_u32 v30, v28, 4, v30
    v_add_u32 v92, s60, v30
    s_mul_i32 s60, s53, 16640
    s_add_u32 s60, s60, 95904
    v_lshl_add_u32 v93, v32, 4, s60
    v_mov_b64 v[36:37], 0
    v_mov_b64 v[38:39], 0
    v_lshrrev_b32 v30, 1, v32
    v_mul_u32_u24 v30, 4160, v30
    v_and_b32 v31, 1, v32
    v_lshl_add_u32 v30, v31, 4, v30
    s_add_u32 s60, s60, 4096
    v_add_u32 v30, s60, v30
    s_mul_i32 s61, s53, 4576
    s_add_u32 s61, s61, 129056
    v_lshl_add_u32 v31, v32, 4, s61
    v_cmp_gt_u32 vcc, 8, v32
    s_nop 1
    v_cndmask_b32 v30, v31, v30, vcc
    s_sub_u32 s60, s62, 32
    v_mov_b32 v31, s60
    v_cmp_eq_u32 vcc, 38, v32
    s_nop 1
    v_cndmask_b32 v30, v30, v31, vcc
    v_cmp_gt_u32 vcc, 39, v32
    s_nop 0
    s_and_saveexec_b64 s[60:61], vcc
    ds_write_b128 v30, v[36:39]
    s_mov_b64 exec, s[60:61]
    s_mul_i32 s60, s53, 16640
    s_lshl_b32 s61, s54, 8
    s_sub_u32 s60, s60, s61
    s_add_u32 s60, s60, 96232
    v_and_b32 v30, 3, v1
    v_mul_u32_u24 v31, 4160, v30
    v_bfe_u32 v30, v1, 2, 2
    v_lshl_add_u32 v30, v28, 1, v30
    v_lshlrev_b32 v30, 3, v30
    v_sub_u32 v31, v31, v30
    v_add_u32 v208, s60, v31
    s_mul_i32 s60, s53, 4576
    s_sub_u32 s64, s60, s61
    s_add_u32 s64, s64, 129488
    v_lshlrev_b32 v31, 5, v27
    v_lshlrev_b32 v30, 4, v28
    v_sub_u32 v31, v31, v30
    v_add_u32 v212, s64, v31
    s_lshl_b32 s61, s54, 11
    s_add_u32 s60, s60, s61
    s_add_u32 s60, s60, 129632
    s_lshl_b32 s64, s53, 12
    s_add_u32 s64, s64, s61
    s_add_u32 s64, s64, 138336
    v_mov_b32 v30, s60
    v_mov_b32 v31, s64
    v_cmp_gt_u32 vcc, 2, v28
    s_nop 1
    v_cndmask_b32 v30, v30, v31, vcc
    v_lshl_add_u32 v30, v27, 5, v30
    v_lshl_add_u32 v213, v28, 4, v30
    s_lshl_b32 s60, s3, 12
    v_lshl_add_u32 v215, v1, 4, s60
    v_xor_b32 v214, 0x1000, v215
    v_and_b32 v30, 1, v28
    v_lshlrev_b32 v30, 9, v30
    v_lshl_add_u32 v30, v27, 5, v30
    v_lshrrev_b32 v31, 1, v28
    v_lshl_add_u32 v216, v31, 4, v30
    s_lshl1_add_u32 s60, s50, s53
    s_and_b32 s60, s60, 7
    s_lshl_b32 s60, s60, 7
    v_xor_b32 v216, s60, v216
    s_cmp_eq_u32 s3, 0
    s_cbranch_scc1 PG_1
    s_cmp_eq_u32 s3, 1
    s_cbranch_scc1 PG_2
    s_cmp_eq_u32 s3, 2
    s_cbranch_scc1 PG_3
HOP_A:
    s_waitcnt vmcnt(9)
    v_readfirstlane_b32 s55, v16
    s_nop 0
    s_add_u32 s55, s55, 8
    s_and_b32 s55, s55, -8
    s_or_b32 s68, s55, s81
    ds_read2st64_b32 v[220:221], v20 offset0:0 offset1:1
    ds_read_b32 v222, v20 offset:512
    ds_read2st64_b32 v[224:225], v20 offset0:3 offset1:4
    ds_read_b32 v226, v20 offset:1280
    ds_read2st64_b32 v[228:229], v20 offset0:6 offset1:7
    v_mov_b32 v223, s55
    v_mov_b32 v227, s55
    v_mov_b32 v231, s55
    v_mov_b32 v239, s68
    s_waitcnt lgkmcnt(0)
    global_store_dwordx4 v219, v[220:223], s[28:29] offset:0 sc1
    global_store_dwordx4 v219, v[224:227], s[28:29] offset:128 sc1
    global_store_dwordx4 v219, v[228:231], s[28:29] offset:256 sc1
    s_mov_b32 s39, 0x3f803f80
    v_dot2_f32_bf16 v232, v100, s39, 0
    v_dot2_f32_bf16 v233, v104, s39, 0
    s_mov_b32 s60, 138336
    v_dot2_f32_bf16 v234, v100, v100, 0
    v_lshl_add_u32 v217, v0, 4, s60
    v_dot2_f32_bf16 v235, v104, v104, 0
    s_lshl_b32 s60, s3, 12
    v_dot2_f32_bf16 v232, v101, s39, v232
    s_add_u32 s60, s60, 65536
    v_dot2_f32_bf16 v233, v105, s39, v233
    v_lshl_add_u32 v254, v1, 4, s60
    v_dot2_f32_bf16 v234, v101, v101, v234
    s_mul_i32 s60, s50, 12288
    v_dot2_f32_bf16 v235, v105, v105, v235
    s_add_u32 s60, s60, 13631488
    v_dot2_f32_bf16 v232, v102, s39, v232
    v_lshrrev_b32 v30, 3, v0
    v_dot2_f32_bf16 v233, v106, s39, v233
    v_mul_u32_u24 v30, 384, v30
    v_dot2_f32_bf16 v234, v102, v102, v234
    v_dot2_f32_bf16 v235, v106, v106, v235
    v_and_b32 v31, 7, v0
    v_dot2_f32_bf16 v232, v103, s39, v232
    v_lshl_add_u32 v30, v31, 4, v30
    v_dot2_f32_bf16 v233, v107, s39, v233
    v_add_u32 v255, s60, v30
    v_dot2_f32_bf16 v234, v103, v103, v234
    s_lshr_b32 s60, s50, 6
    v_dot2_f32_bf16 v235, v107, v107, v235
    s_lshl_b32 s60, s60, 12
    v_permlane32_swap_b32 v232, v233
    s_and_b32 s61, s50, 0x38
    v_permlane32_swap_b32 v234, v235
    s_lshl_b32 s61, s61, 4
    v_add_f32 v232, v232, v233
    s_add_u32 s60, s60, s61
    v_add_f32 v234, v234, v235
    s_add_u32 s60, s60, 65548
    s_nop 0
    v_permlane16_swap_b32 v232, v234
    v_lshl_add_u32 v99, v31, 4, s60
    v_add_f32 v232, v232, v234
    s_nop 1
    v_add_f32_dpp v232, v232, v232 row_ror:8 row_mask:0xf bank_mask:0xf
    s_mul_i32 s60, s51, 180224
    s_nop 0
    v_add_f32_dpp v232, v232, v232 row_ror:4 row_mask:0xf bank_mask:0xf
    s_mul_i32 s61, s3, 11264
    s_nop 0
    v_add_f32_dpp v232, v232, v232 row_ror:2 row_mask:0xf bank_mask:0xf
    s_add_u32 s61, s61, s60
    s_nop 0
    v_add_f32_dpp v232, v232, v232 row_ror:1 row_mask:0xf bank_mask:0xf
    s_lshl_b32 s62, s52, 10
    v_mul_f32 v232, 0x3b000000, v232
    s_cmp_eq_u32 s52, 7
    s_cselect_b32 s62, 1073741824, s62
    v_mov_b32 v234, v232
    s_add_u32 s61, s61, s62
    s_nop 0
    v_permlane16_swap_b32 v232, v234
    v_lshl_add_u32 v128, v1, 4, s61
    v_fma_f32 v234, -v232, v232, v234
    s_lshl_b32 s61, s52, 1
    v_max_f32 v234, 0, v234
    s_add_u32 s61, s61, s53
    v_cvt_pk_bf16_f32 v234, 0, v234
    v_add_f32 v234, 0x3727c5ac, v234
    s_and_b32 s62, s61, 3
    v_cvt_pk_bf16_f32 v234, 0, v234
    s_mul_i32 s62, s62, 11264
    v_sqrt_f32 v234, v234
    s_add_u32 s60, s60, s62
    v_mov_b32 v233, v232
    s_lshr_b32 s61, s61, 2
    v_cvt_pk_bf16_f32 v234, 0, v234
    s_lshl_b32 s61, s61, 10
    v_rcp_f32 v236, v234
    s_add_u32 s60, s60, s61
    v_permlane32_swap_b32 v232, v233
    s_mul_i32 s61, s54, 90112
    v_mov_b32 v237, v236
    s_add_u32 s60, s60, s61
    s_nop 0
    v_permlane32_swap_b32 v236, v237
    s_add_u32 s60, s60, 7168
    v_cvt_pk_bf16_f32 v238, v232, v233
    v_lshl_add_u32 v218, v1, 4, s60
    s_lshr_b32 s38, s50, 6
    s_lshl_b32 s38, s38, 12
    s_and_b32 s39, s50, 63
    s_lshl_b32 s39, s39, 4
    s_add_u32 s38, s38, s39
    s_lshl_b32 s39, s3, 10
    s_add_u32 s38, s38, s39
    s_add_u32 s38, s38, 65536
    v_mov_b32 v232, s38
    s_waitcnt vmcnt(10)
    s_mov_b64 exec, 1
    global_store_dwordx4 v232, v[236:239], s[28:29] sc1
    s_mov_b64 exec, -1
    s_waitcnt vmcnt(8)
    v_readfirstlane_b32 s56, v15
    s_lshl_b32 s60, s53, 4
    s_lshr_b32 s61, s56, s60
    s_lshl_b32 s61, s61, 16
    v_mov_b32 v24, 0x3fb8aa3b
    v_mul_f32 v25, s61, v24
    v_exp_f32 v25, v25
    v_lshlrev_b32 v138, 16, v138
    v_mul_f32 v138, v138, v24
    v_exp_f32 v138, v138
    v_lshlrev_b32 v139, 16, v139
    s_waitcnt vmcnt(7)
    v_lshlrev_b32 v140, 16, v140
    s_waitcnt vmcnt(6)
    v_lshlrev_b32 v141, 16, v141
    v_cvt_pk_bf16_f32 v25, 0, v25
    v_cvt_pk_bf16_f32 v138, 0, v138
    v_mul_f32 v138, v138, v25
    v_mul_f32 v139, v139, v25
    v_add_f32 v41, v25, v25
    v_mul_f32 v138, 0xbfb8aa3b, v138
    v_mul_f32 v139, 0x3e22f983, v139
    v_mul_f32 v40, v140, v41
    v_mul_f32 v41, v141, v41
    v_exp_f32 v30, v138
    v_fract_f32 v31, v139
    v_cos_f32 v24, v31
    v_sin_f32 v25, v31
    v_mul_f32 v32, 0x41800000, v138
    v_mul_f32 v33, 0x41800000, v139
    v_exp_f32 v32, v32
    v_fract_f32 v33, v33
    v_cos_f32 v26, v33
    v_sin_f32 v27, v33
    v_mul_f32 v34, 0x43800000, v138
    v_mul_f32 v35, 0x43800000, v139
    v_exp_f32 v34, v34
    v_fract_f32 v35, v35
    v_cos_f32 v28, v35
    v_sin_f32 v29, v35
    v_mul_f32 v24, v24, v30
    v_mul_f32 v25, v25, v30
    v_mul_f32 v26, v26, v32
    v_mul_f32 v27, -v27, v32
    v_mul_f32 v28, v28, v34
    v_mul_f32 v29, v29, v34
    v_mov_b32 v97, 0x3f80
    ds_write_addtid_b32 v97 offset:13056
    v_cvt_pk_bf16_f32 v94, v40, v41
    v_cvt_pk_bf16_f32 v95, v26, v27
    ds_write_addtid_b32 v94 offset:0
    ds_write_addtid_b32 v95 offset:13328
    v_pk_mul_f32 v[62:63], v[40:41], v[24:25] op_sel:[1,1] op_sel_hi:[1,0] neg_lo:[0,1]
    v_pk_mul_f32 v[36:37], v[26:27], v[26:27] op_sel:[1,1] op_sel_hi:[1,0] neg_lo:[0,1]
    v_pk_fma_f32 v[56:57], v[40:41], v[24:25], v[62:63] op_sel:[0,0,0] op_sel_hi:[0,1,1]
    v_pk_fma_f32 v[60:61], v[26:27], v[26:27], v[36:37] op_sel:[0,0,0] op_sel_hi:[0,1,1]
    v_cvt_pk_bf16_f32 v96, v56, v57
    v_cvt_pk_bf16_f32 v97, v60, v61
    ds_write_addtid_b32 v96 offset:272
    ds_write_addtid_b32 v97 offset:13600
    s_add_u32 s38, s32, 0
    s_addc_u32 s39, s33, 0
    global_load_dword a0, v248, s[38:39] offset:-2752
    global_load_dword a1, v248, s[38:39] offset:0
    v_pk_mul_f32 v[62:63], v[56:57], v[24:25] op_sel:[1,1] op_sel_hi:[1,0] neg_lo:[0,1]
    v_pk_mul_f32 v[36:37], v[60:61], v[26:27] op_sel:[1,1] op_sel_hi:[1,0] neg_lo:[0,1]
    v_pk_fma_f32 v[42:43], v[56:57], v[24:25], v[62:63] op_sel:[0,0,0] op_sel_hi:[0,1,1]
    v_pk_fma_f32 v[58:59], v[60:61], v[26:27], v[36:37] op_sel:[0,0,0] op_sel_hi:[0,1,1]
    v_cvt_pk_bf16_f32 v94, v42, v43
    v_cvt_pk_bf16_f32 v95, v58, v59
    ds_write_addtid_b32 v94 offset:544
    ds_write_addtid_b32 v95 offset:13872
    global_load_dword a2, v248, s[38:39] offset:2752
    global_load_dword a3, v249, s[38:39] offset:-2752
    v_pk_mul_f32 v[62:63], v[42:43], v[24:25] op_sel:[1,1] op_sel_hi:[1,0] neg_lo:[0,1]
    v_pk_mul_f32 v[36:37], v[58:59], v[26:27] op_sel:[1,1] op_sel_hi:[1,0] neg_lo:[0,1]
    v_pk_fma_f32 v[56:57], v[42:43], v[24:25], v[62:63] op_sel:[0,0,0] op_sel_hi:[0,1,1]
    v_pk_fma_f32 v[60:61], v[58:59], v[26:27], v[36:37] op_sel:[0,0,0] op_sel_hi:[0,1,1]
    v_cvt_pk_bf16_f32 v96, v56, v57
    v_cvt_pk_bf16_f32 v97, v60, v61
    ds_write_addtid_b32 v96 offset:816
    ds_write_addtid_b32 v97 offset:14144
    global_load_dword a4, v249, s[38:39] offset:0
    global_load_dword a5, v249, s[38:39] offset:2752
    v_pk_mul_f32 v[62:63], v[56:57], v[24:25] op_sel:[1,1] op_sel_hi:[1,0] neg_lo:[0,1]
    v_pk_mul_f32 v[36:37], v[60:61], v[26:27] op_sel:[1,1] op_sel_hi:[1,0] neg_lo:[0,1]
    v_pk_fma_f32 v[44:45], v[56:57], v[24:25], v[62:63] op_sel:[0,0,0] op_sel_hi:[0,1,1]
    v_pk_fma_f32 v[58:59], v[60:61], v[26:27], v[36:37] op_sel:[0,0,0] op_sel_hi:[0,1,1]
    v_cvt_pk_bf16_f32 v94, v44, v45
    v_cvt_pk_bf16_f32 v95, v58, v59
    ds_write_addtid_b32 v94 offset:1088
    ds_write_addtid_b32 v95 offset:14416
    global_load_dword a6, v250, s[38:39] offset:-2752
    global_load_dword a7, v250, s[38:39] offset:0
    v_pk_mul_f32 v[62:63], v[44:45], v[24:25] op_sel:[1,1] op_sel_hi:[1,0] neg_lo:[0,1]
    v_pk_mul_f32 v[36:37], v[58:59], v[26:27] op_sel:[1,1] op_sel_hi:[1,0] neg_lo:[0,1]
    v_pk_fma_f32 v[56:57], v[44:45], v[24:25], v[62:63] op_sel:[0,0,0] op_sel_hi:[0,1,1]
    v_pk_fma_f32 v[60:61], v[58:59], v[26:27], v[36:37] op_sel:[0,0,0] op_sel_hi:[0,1,1]
    v_cvt_pk_bf16_f32 v96, v56, v57
    v_cvt_pk_bf16_f32 v97, v60, v61
    ds_write_addtid_b32 v96 offset:1360
    ds_write_addtid_b32 v97 offset:14688
    s_add_u32 s38, s36, 0
    s_addc_u32 s39, s37, 0
    global_load_dword a8, v248, s[38:39] offset:-2752
    global_load_dword a9, v248, s[38:39] offset:0
    v_pk_mul_f32 v[62:63], v[56:57], v[24:25] op_sel:[1,1] op_sel_hi:[1,0] neg_lo:[0,1]
    v_pk_mul_f32 v[36:37], v[60:61], v[26:27] op_sel:[1,1] op_sel_hi:[1,0] neg_lo:[0,1]
    v_pk_fma_f32 v[46:47], v[56:57], v[24:25], v[62:63] op_sel:[0,0,0] op_sel_hi:[0,1,1]
    v_pk_fma_f32 v[58:59], v[60:61], v[26:27], v[36:37] op_sel:[0,0,0] op_sel_hi:[0,1,1]
    v_cvt_pk_bf16_f32 v94, v46, v47
    v_cvt_pk_bf16_f32 v95, v58, v59
    ds_write_addtid_b32 v94 offset:1632
    ds_write_addtid_b32 v95 offset:14960
    global_load_dword a10, v248, s[38:39] offset:2752
    global_load_dword a11, v249, s[38:39] offset:-2752
    v_pk_mul_f32 v[62:63], v[46:47], v[24:25] op_sel:[1,1] op_sel_hi:[1,0] neg_lo:[0,1]
    v_pk_mul_f32 v[36:37], v[58:59], v[26:27] op_sel:[1,1] op_sel_hi:[1,0] neg_lo:[0,1]
    v_pk_fma_f32 v[56:57], v[46:47], v[24:25], v[62:63] op_sel:[0,0,0] op_sel_hi:[0,1,1]
    v_pk_fma_f32 v[60:61], v[58:59], v[26:27], v[36:37] op_sel:[0,0,0] op_sel_hi:[0,1,1]
    v_cvt_pk_bf16_f32 v96, v56, v57
    v_cvt_pk_bf16_f32 v97, v60, v61
    ds_write_addtid_b32 v96 offset:1904
    ds_write_addtid_b32 v97 offset:15232
    global_load_dword a12, v249, s[38:39] offset:0
    global_load_dword a13, v249, s[38:39] offset:2752
    v_pk_mul_f32 v[62:63], v[56:57], v[24:25] op_sel:[1,1] op_sel_hi:[1,0] neg_lo:[0,1]
    v_pk_mul_f32 v[36:37], v[60:61], v[26:27] op_sel:[1,1] op_sel_hi:[1,0] neg_lo:[0,1]
    v_pk_fma_f32 v[48:49], v[56:57], v[24:25], v[62:63] op_sel:[0,0,0] op_sel_hi:[0,1,1]
    v_pk_fma_f32 v[58:59], v[60:61], v[26:27], v[36:37] op_sel:[0,0,0] op_sel_hi:[0,1,1]
    v_cvt_pk_bf16_f32 v94, v48, v49
    v_cvt_pk_bf16_f32 v95, v58, v59
    ds_write_addtid_b32 v94 offset:2176
    ds_write_addtid_b32 v95 offset:15504
    global_load_dword a14, v250, s[38:39] offset:-2752
    global_load_dword a15, v250, s[38:39] offset:0
    v_pk_mul_f32 v[62:63], v[48:49], v[24:25] op_sel:[1,1] op_sel_hi:[1,0] neg_lo:[0,1]
    v_pk_mul_f32 v[36:37], v[58:59], v[26:27] op_sel:[1,1] op_sel_hi:[1,0] neg_lo:[0,1]
    v_pk_fma_f32 v[56:57], v[48:49], v[24:25], v[62:63] op_sel:[0,0,0] op_sel_hi:[0,1,1]
    v_pk_fma_f32 v[60:61], v[58:59], v[26:27], v[36:37] op_sel:[0,0,0] op_sel_hi:[0,1,1]
    v_cvt_pk_bf16_f32 v96, v56, v57
    v_cvt_pk_bf16_f32 v97, v60, v61
    ds_write_addtid_b32 v96 offset:2448
    ds_write_addtid_b32 v97 offset:15776
    s_branch PO_1
.p2align 12
PG_1:
    s_branch HOP_A
PO_1:
    s_add_u32 s38, s34, 0
    s_addc_u32 s39, s35, 0
    global_load_dword a16, v248, s[38:39] offset:-2752
    global_load_dword a17, v248, s[38:39] offset:0
    v_pk_mul_f32 v[62:63], v[56:57], v[24:25] op_sel:[1,1] op_sel_hi:[1,0] neg_lo:[0,1]
    v_pk_mul_f32 v[36:37], v[60:61], v[26:27] op_sel:[1,1] op_sel_hi:[1,0] neg_lo:[0,1]
    v_pk_fma_f32 v[50:51], v[56:57], v[24:25], v[62:63] op_sel:[0,0,0] op_sel_hi:[0,1,1]
    v_pk_fma_f32 v[58:59], v[60:61], v[26:27], v[36:37] op_sel:[0,0,0] op_sel_hi:[0,1,1]
    v_cvt_pk_bf16_f32 v94, v50, v51
    v_cvt_pk_bf16_f32 v95, v58, v59
    ds_write_addtid_b32 v94 offset:2720
    ds_write_addtid_b32 v95 offset:16048
    global_load_dword a18, v248, s[38:39] offset:2752
    global_load_dword a19, v249, s[38:39] offset:-2752
    v_pk_mul_f32 v[62:63], v[50:51], v[24:25] op_sel:[1,1] op_sel_hi:[1,0] neg_lo:[0,1]
    v_pk_mul_f32 v[36:37], v[58:59], v[26:27] op_sel:[1,1] op_sel_hi:[1,0] neg_lo:[0,1]
    v_pk_fma_f32 v[56:57], v[50:51], v[24:25], v[62:63] op_sel:[0,0,0] op_sel_hi:[0,1,1]
    v_pk_fma_f32 v[60:61], v[58:59], v[26:27], v[36:37] op_sel:[0,0,0] op_sel_hi:[0,1,1]
    v_cvt_pk_bf16_f32 v96, v56, v57
    v_cvt_pk_bf16_f32 v97, v60, v61
    ds_write_addtid_b32 v96 offset:2992
    ds_write_addtid_b32 v97 offset:16320
    global_load_dword a20, v249, s[38:39] offset:0
    global_load_dword a21, v249, s[38:39] offset:2752
    v_pk_mul_f32 v[62:63], v[56:57], v[24:25] op_sel:[1,1] op_sel_hi:[1,0] neg_lo:[0,1]
    v_pk_mul_f32 v[36:37], v[60:61], v[26:27] op_sel:[1,1] op_sel_hi:[1,0] neg_lo:[0,1]
    v_pk_fma_f32 v[52:53], v[56:57], v[24:25], v[62:63] op_sel:[0,0,0] op_sel_hi:[0,1,1]
    v_pk_fma_f32 v[58:59], v[60:61], v[26:27], v[36:37] op_sel:[0,0,0] op_sel_hi:[0,1,1]
    v_cvt_pk_bf16_f32 v94, v52, v53
    v_cvt_pk_bf16_f32 v95, v58, v59
    ds_write_addtid_b32 v94 offset:3264
    ds_write_addtid_b32 v95 offset:16592
    global_load_dword a22, v250, s[38:39] offset:-2752
    global_load_dword a23, v250, s[38:39] offset:0
    v_pk_mul_f32 v[62:63], v[52:53], v[24:25] op_sel:[1,1] op_sel_hi:[1,0] neg_lo:[0,1]
    v_pk_mul_f32 v[36:37], v[58:59], v[26:27] op_sel:[1,1] op_sel_hi:[1,0] neg_lo:[0,1]
    v_pk_fma_f32 v[56:57], v[52:53], v[24:25], v[62:63] op_sel:[0,0,0] op_sel_hi:[0,1,1]
    v_pk_fma_f32 v[60:61], v[58:59], v[26:27], v[36:37] op_sel:[0,0,0] op_sel_hi:[0,1,1]
    v_cvt_pk_bf16_f32 v96, v56, v57
    v_cvt_pk_bf16_f32 v97, v60, v61
    ds_write_addtid_b32 v96 offset:3536
    ds_write_addtid_b32 v97 offset:16864
    s_add_u32 s38, s32, 176128
    s_addc_u32 s39, s33, 0
    global_load_dword a24, v248, s[38:39] offset:-2752
    global_load_dword a25, v248, s[38:39] offset:0
    v_pk_mul_f32 v[62:63], v[56:57], v[24:25] op_sel:[1,1] op_sel_hi:[1,0] neg_lo:[0,1]
    v_pk_mul_f32 v[36:37], v[60:61], v[26:27] op_sel:[1,1] op_sel_hi:[1,0] neg_lo:[0,1]
    v_pk_fma_f32 v[54:55], v[56:57], v[24:25], v[62:63] op_sel:[0,0,0] op_sel_hi:[0,1,1]
    v_pk_fma_f32 v[58:59], v[60:61], v[26:27], v[36:37] op_sel:[0,0,0] op_sel_hi:[0,1,1]
    v_cvt_pk_bf16_f32 v94, v54, v55
    v_cvt_pk_bf16_f32 v95, v58, v59
    ds_write_addtid_b32 v94 offset:3808
    ds_write_addtid_b32 v95 offset:17136
    global_load_dword a26, v248, s[38:39] offset:2752
    global_load_dword a27, v249, s[38:39] offset:-2752
    v_pk_mul_f32 v[62:63], v[54:55], v[24:25] op_sel:[1,1] op_sel_hi:[1,0] neg_lo:[0,1]
    v_pk_mul_f32 v[36:37], v[28:29], v[28:29] op_sel:[1,1] op_sel_hi:[1,0] neg_lo:[0,1]
    v_pk_fma_f32 v[56:57], v[54:55], v[24:25], v[62:63] op_sel:[0,0,0] op_sel_hi:[0,1,1]
    v_pk_fma_f32 v[30:31], v[28:29], v[28:29], v[36:37] op_sel:[0,0,0] op_sel_hi:[0,1,1]
    v_cvt_pk_bf16_f32 v96, v56, v57
    ds_write_addtid_b32 v96 offset:4080
    global_load_dword a28, v249, s[38:39] offset:0
    global_load_dword a29, v249, s[38:39] offset:2752
    v_pk_mul_f32 v[62:63], v[30:31], v[28:29] op_sel:[1,1] op_sel_hi:[1,0] neg_lo:[0,1]
    v_pk_mul_f32 v[56:57], v[30:31], v[30:31] op_sel:[1,1] op_sel_hi:[1,0] neg_lo:[0,1]
    v_pk_fma_f32 v[32:33], v[30:31], v[28:29], v[62:63] op_sel:[0,0,0] op_sel_hi:[0,1,1]
    v_pk_fma_f32 v[34:35], v[30:31], v[30:31], v[56:57] op_sel:[0,0,0] op_sel_hi:[0,1,1]
    ds_read_b128 v[144:147], v92 offset:13056
    v_pk_mul_f32 v[62:63], v[34:35], v[28:29] op_sel:[1,1] op_sel_hi:[1,0] neg_lo:[0,1]
    v_pk_mul_f32 v[56:57], v[34:35], v[30:31] op_sel:[1,1] op_sel_hi:[1,0] neg_lo:[0,1]
    v_pk_fma_f32 v[36:37], v[34:35], v[28:29], v[62:63] op_sel:[0,0,0] op_sel_hi:[0,1,1]
    v_pk_fma_f32 v[38:39], v[34:35], v[30:31], v[56:57] op_sel:[0,0,0] op_sel_hi:[0,1,1]
    ds_read_b128 v[148:151], v92 offset:13120
    v_pk_mul_f32 v[62:63], v[34:35], v[32:33] op_sel:[1,1] op_sel_hi:[1,0] neg_lo:[0,1]
    v_pk_mul_f32 v[56:57], v[34:35], v[34:35] op_sel:[1,1] op_sel_hi:[1,0] neg_lo:[0,1]
    v_pk_fma_f32 v[24:25], v[34:35], v[32:33], v[62:63] op_sel:[0,0,0] op_sel_hi:[0,1,1]
    v_pk_fma_f32 v[26:27], v[34:35], v[34:35], v[56:57] op_sel:[0,0,0] op_sel_hi:[0,1,1]
    ds_read_b128 v[152:155], v92 offset:13184
    v_pk_mul_f32 v[62:63], v[40:41], v[28:29] op_sel:[1,1] op_sel_hi:[1,0] neg_lo:[0,1]
    v_pk_mul_f32 v[56:57], v[42:43], v[28:29] op_sel:[1,1] op_sel_hi:[1,0] neg_lo:[0,1]
    v_pk_fma_f32 v[58:59], v[40:41], v[28:29], v[62:63] op_sel:[0,0,0] op_sel_hi:[0,1,1]
    v_pk_fma_f32 v[60:61], v[42:43], v[28:29], v[56:57] op_sel:[0,0,0] op_sel_hi:[0,1,1]
    v_cvt_pk_bf16_f32 v97, v58, v59
    v_cvt_pk_bf16_f32 v94, v60, v61
    ds_write_addtid_b32 v97 offset:4352
    ds_write_addtid_b32 v94 offset:4624
    ds_read_b128 v[156:159], v92 offset:13248
    global_load_dword a30, v250, s[38:39] offset:-2752
    global_load_dword a31, v250, s[38:39] offset:0
    v_pk_mul_f32 v[62:63], v[44:45], v[28:29] op_sel:[1,1] op_sel_hi:[1,0] neg_lo:[0,1]
    v_pk_mul_f32 v[56:57], v[46:47], v[28:29] op_sel:[1,1] op_sel_hi:[1,0] neg_lo:[0,1]
    v_pk_fma_f32 v[58:59], v[44:45], v[28:29], v[62:63] op_sel:[0,0,0] op_sel_hi:[0,1,1]
    v_pk_fma_f32 v[60:61], v[46:47], v[28:29], v[56:57] op_sel:[0,0,0] op_sel_hi:[0,1,1]
    v_cvt_pk_bf16_f32 v95, v58, v59
    v_cvt_pk_bf16_f32 v96, v60, v61
    ds_write_addtid_b32 v95 offset:4896
    ds_write_addtid_b32 v96 offset:5168
    ds_read_b128 v[160:163], v92 offset:0
    s_add_u32 s38, s36, 176128
    s_addc_u32 s39, s37, 0
    global_load_dword a32, v248, s[38:39] offset:-2752
    global_load_dword a33, v248, s[38:39] offset:0
    v_pk_mul_f32 v[62:63], v[48:49], v[28:29] op_sel:[1,1] op_sel_hi:[1,0] neg_lo:[0,1]
    v_pk_mul_f32 v[56:57], v[50:51], v[28:29] op_sel:[1,1] op_sel_hi:[1,0] neg_lo:[0,1]
    v_pk_fma_f32 v[58:59], v[48:49], v[28:29], v[62:63] op_sel:[0,0,0] op_sel_hi:[0,1,1]
    v_pk_fma_f32 v[60:61], v[50:51], v[28:29], v[56:57] op_sel:[0,0,0] op_sel_hi:[0,1,1]
    v_cvt_pk_bf16_f32 v97, v58, v59
    v_cvt_pk_bf16_f32 v94, v60, v61
    ds_write_addtid_b32 v97 offset:5440
    ds_write_addtid_b32 v94 offset:5712
    ds_read_b128 v[164:167], v92 offset:64
    global_load_dword a34, v248, s[38:39] offset:2752
    global_load_dword a35, v249, s[38:39] offset:-2752
    v_pk_mul_f32 v[62:63], v[52:53], v[28:29] op_sel:[1,1] op_sel_hi:[1,0] neg_lo:[0,1]
    v_pk_mul_f32 v[56:57], v[54:55], v[28:29] op_sel:[1,1] op_sel_hi:[1,0] neg_lo:[0,1]
    v_pk_fma_f32 v[58:59], v[52:53], v[28:29], v[62:63] op_sel:[0,0,0] op_sel_hi:[0,1,1]
    v_pk_fma_f32 v[60:61], v[54:55], v[28:29], v[56:57] op_sel:[0,0,0] op_sel_hi:[0,1,1]
    v_cvt_pk_bf16_f32 v95, v58, v59
    v_cvt_pk_bf16_f32 v96, v60, v61
    ds_write_addtid_b32 v95 offset:5984
    ds_write_addtid_b32 v96 offset:6256
    ds_read_b128 v[168:171], v92 offset:128
    global_load_dword a36, v249, s[38:39] offset:0
    global_load_dword a37, v249, s[38:39] offset:2752
    v_pk_mul_f32 v[62:63], v[40:41], v[30:31] op_sel:[1,1] op_sel_hi:[1,0] neg_lo:[0,1]
    v_pk_mul_f32 v[56:57], v[44:45], v[30:31] op_sel:[1,1] op_sel_hi:[1,0] neg_lo:[0,1]
    v_pk_fma_f32 v[58:59], v[40:41], v[30:31], v[62:63] op_sel:[0,0,0] op_sel_hi:[0,1,1]
    v_pk_fma_f32 v[60:61], v[44:45], v[30:31], v[56:57] op_sel:[0,0,0] op_sel_hi:[0,1,1]
    v_cvt_pk_bf16_f32 v97, v58, v59
    v_cvt_pk_bf16_f32 v94, v60, v61
    ds_write_addtid_b32 v97 offset:6528
    ds_write_addtid_b32 v94 offset:6800
    ds_read_b128 v[172:175], v92 offset:192
    global_load_dword a38, v250, s[38:39] offset:-2752
    global_load_dword a39, v250, s[38:39] offset:0
    v_pk_mul_f32 v[62:63], v[48:49], v[30:31] op_sel:[1,1] op_sel_hi:[1,0] neg_lo:[0,1]
    v_pk_mul_f32 v[56:57], v[52:53], v[30:31] op_sel:[1,1] op_sel_hi:[1,0] neg_lo:[0,1]
    v_pk_fma_f32 v[58:59], v[48:49], v[30:31], v[62:63] op_sel:[0,0,0] op_sel_hi:[0,1,1]
    v_pk_fma_f32 v[60:61], v[52:53], v[30:31], v[56:57] op_sel:[0,0,0] op_sel_hi:[0,1,1]
    v_cvt_pk_bf16_f32 v95, v58, v59
    v_cvt_pk_bf16_f32 v96, v60, v61
    ds_write_addtid_b32 v95 offset:7072
    ds_write_addtid_b32 v96 offset:7344
    s_add_u32 s38, s34, 176128
    s_addc_u32 s39, s35, 0
    global_load_dword a40, v248, s[38:39] offset:-2752
    global_load_dword a41, v248, s[38:39] offset:0
    v_pk_mul_f32 v[62:63], v[40:41], v[32:33] op_sel:[1,1] op_sel_hi:[1,0] neg_lo:[0,1]
    v_pk_mul_f32 v[56:57], v[44:45], v[32:33] op_sel:[1,1] op_sel_hi:[1,0] neg_lo:[0,1]
    v_pk_fma_f32 v[58:59], v[40:41], v[32:33], v[62:63] op_sel:[0,0,0] op_sel_hi:[0,1,1]
    v_pk_fma_f32 v[60:61], v[44:45], v[32:33], v[56:57] op_sel:[0,0,0] op_sel_hi:[0,1,1]
    v_cvt_pk_bf16_f32 v97, v58, v59
    v_cvt_pk_bf16_f32 v94, v60, v61
    ds_write_addtid_b32 v97 offset:7616
    ds_write_addtid_b32 v94 offset:7888
    global_load_dword a42, v248, s[38:39] offset:2752
    global_load_dword a43, v249, s[38:39] offset:-2752
    v_pk_mul_f32 v[62:63], v[48:49], v[32:33] op_sel:[1,1] op_sel_hi:[1,0] neg_lo:[0,1]
    v_pk_mul_f32 v[56:57], v[52:53], v[32:33] op_sel:[1,1] op_sel_hi:[1,0] neg_lo:[0,1]
    v_pk_fma_f32 v[58:59], v[48:49], v[32:33], v[62:63] op_sel:[0,0,0] op_sel_hi:[0,1,1]
    v_pk_fma_f32 v[60:61], v[52:53], v[32:33], v[56:57] op_sel:[0,0,0] op_sel_hi:[0,1,1]
    v_cvt_pk_bf16_f32 v95, v58, v59
    v_cvt_pk_bf16_f32 v96, v60, v61
    ds_write_addtid_b32 v95 offset:8160
    ds_write_addtid_b32 v96 offset:8432
    ds_read_b128 v[176:179], v92 offset:4352
    global_load_dword a44, v249, s[38:39] offset:0
    global_load_dword a45, v249, s[38:39] offset:2752
    v_pk_mul_f32 v[62:63], v[40:41], v[34:35] op_sel:[1,1] op_sel_hi:[1,0] neg_lo:[0,1]
    v_pk_mul_f32 v[56:57], v[48:49], v[34:35] op_sel:[1,1] op_sel_hi:[1,0] neg_lo:[0,1]
    v_pk_fma_f32 v[58:59], v[40:41], v[34:35], v[62:63] op_sel:[0,0,0] op_sel_hi:[0,1,1]
    v_pk_fma_f32 v[60:61], v[48:49], v[34:35], v[56:57] op_sel:[0,0,0] op_sel_hi:[0,1,1]
    v_cvt_pk_bf16_f32 v97, v58, v59
    v_cvt_pk_bf16_f32 v94, v60, v61
    ds_write_addtid_b32 v97 offset:8704
    ds_write_addtid_b32 v94 offset:8976
    ds_read_b128 v[180:183], v92 offset:4416
    global_load_dword a46, v250, s[38:39] offset:-2752
    global_load_dword a47, v250, s[38:39] offset:0
    v_pk_mul_f32 v[62:63], v[40:41], v[36:37] op_sel:[1,1] op_sel_hi:[1,0] neg_lo:[0,1]
    v_pk_mul_f32 v[56:57], v[48:49], v[36:37] op_sel:[1,1] op_sel_hi:[1,0] neg_lo:[0,1]
    v_pk_fma_f32 v[58:59], v[40:41], v[36:37], v[62:63] op_sel:[0,0,0] op_sel_hi:[0,1,1]
    v_pk_fma_f32 v[60:61], v[48:49], v[36:37], v[56:57] op_sel:[0,0,0] op_sel_hi:[0,1,1]
    v_cvt_pk_bf16_f32 v95, v58, v59
    v_cvt_pk_bf16_f32 v96, v60, v61
    ds_write_addtid_b32 v95 offset:9248
    ds_write_addtid_b32 v96 offset:9520
    ds_read_b128 v[184:187], v92 offset:4480
    s_add_u32 s38, s32, 352256
    s_addc_u32 s39, s33, 0
    global_load_dword a48, v248, s[38:39] offset:-2752
    global_load_dword a49, v248, s[38:39] offset:0
    v_pk_mul_f32 v[62:63], v[40:41], v[38:39] op_sel:[1,1] op_sel_hi:[1,0] neg_lo:[0,1]
    v_pk_mul_f32 v[56:57], v[48:49], v[38:39] op_sel:[1,1] op_sel_hi:[1,0] neg_lo:[0,1]
    v_pk_fma_f32 v[58:59], v[40:41], v[38:39], v[62:63] op_sel:[0,0,0] op_sel_hi:[0,1,1]
    v_pk_fma_f32 v[60:61], v[48:49], v[38:39], v[56:57] op_sel:[0,0,0] op_sel_hi:[0,1,1]
    v_cvt_pk_bf16_f32 v97, v58, v59
    v_cvt_pk_bf16_f32 v94, v60, v61
    ds_write_addtid_b32 v97 offset:9792
    ds_write_addtid_b32 v94 offset:10064
    ds_read_b128 v[188:191], v92 offset:4544
    global_load_dword a50, v248, s[38:39] offset:2752
    global_load_dword a51, v249, s[38:39] offset:-2752
    v_pk_mul_f32 v[62:63], v[40:41], v[24:25] op_sel:[1,1] op_sel_hi:[1,0] neg_lo:[0,1]
    v_pk_mul_f32 v[56:57], v[48:49], v[24:25] op_sel:[1,1] op_sel_hi:[1,0] neg_lo:[0,1]
    v_pk_fma_f32 v[58:59], v[40:41], v[24:25], v[62:63] op_sel:[0,0,0] op_sel_hi:[0,1,1]
    v_pk_fma_f32 v[60:61], v[48:49], v[24:25], v[56:57] op_sel:[0,0,0] op_sel_hi:[0,1,1]
    v_cvt_pk_bf16_f32 v95, v58, v59
    v_cvt_pk_bf16_f32 v96, v60, v61
    ds_write_addtid_b32 v95 offset:10336
    ds_write_addtid_b32 v96 offset:10608
    global_load_dword a52, v249, s[38:39] offset:0
    global_load_dword a53, v249, s[38:39] offset:2752
    v_pk_mul_f32 v[62:63], v[40:41], v[26:27] op_sel:[1,1] op_sel_hi:[1,0] neg_lo:[0,1]
    v_pk_fma_f32 v[58:59], v[40:41], v[26:27], v[62:63] op_sel:[0,0,0] op_sel_hi:[0,1,1]
    v_cvt_pk_bf16_f32 v97, v58, v59
    ds_write_addtid_b32 v97 offset:10880
    global_load_dword a54, v250, s[38:39] offset:-2752
    global_load_dword a55, v250, s[38:39] offset:0
    ds_read_b128 v[192:195], v92 offset:8704
    ds_read_b128 v[196:199], v92 offset:8768
    ds_read_b128 v[200:203], v92 offset:8832
    ds_read_b128 v[204:207], v92 offset:8896
    global_load_dwordx4 v[220:223], v255, s[28:29] offset:0 sc1
    global_load_dwordx4 v[224:227], v255, s[28:29] offset:128 sc1
    global_load_dwordx4 v[228:231], v255, s[28:29] offset:256 sc1
    global_load_dwordx4 v[232:235], v254, s[28:29] offset:0 sc1
    global_load_dwordx4 v[236:239], v254, s[28:29] offset:1024 sc1
    global_load_dwordx4 v[240:243], v254, s[28:29] offset:2048 sc1
    global_load_dwordx4 v[244:247], v254, s[28:29] offset:3072 sc1
    global_load_dword v98, v99, s[28:29] sc1
    s_waitcnt lgkmcnt(15)
    v_mfma_f32_16x16x32_bf16 v[24:27], v[160:163], v[144:147], 0
    v_mfma_f32_16x16x32_bf16 v[28:31], v[176:179], v[144:147], 0
    v_mfma_f32_16x16x32_bf16 v[24:27], v[164:167], v[148:151], v[24:27]
    s_waitcnt lgkmcnt(13)
    v_mfma_f32_16x16x32_bf16 v[28:31], v[180:183], v[148:151], v[28:31]
    v_mfma_f32_16x16x32_bf16 v[24:27], v[168:171], v[152:155], v[24:27]
    s_waitcnt lgkmcnt(10)
    v_mfma_f32_16x16x32_bf16 v[28:31], v[184:187], v[152:155], v[28:31]
    v_mfma_f32_16x16x32_bf16 v[24:27], v[172:175], v[156:159], v[24:27]
    s_waitcnt lgkmcnt(7)
    v_mfma_f32_16x16x32_bf16 v[28:31], v[188:191], v[156:159], v[28:31]
    s_waitcnt lgkmcnt(3)
    v_mfma_f32_16x16x32_bf16 v[32:35], v[192:195], v[144:147], 0
    s_waitcnt lgkmcnt(2)
    v_mfma_f32_16x16x32_bf16 v[32:35], v[196:199], v[148:151], v[32:35]
    s_nop 1
    ds_write_b32 v86, v24
    s_waitcnt lgkmcnt(2)
    v_mfma_f32_16x16x32_bf16 v[32:35], v[200:203], v[152:155], v[32:35]
    ds_write_b32 v87, v25
    s_waitcnt lgkmcnt(2)
    v_mfma_f32_16x16x32_bf16 v[32:35], v[204:207], v[156:159], v[32:35]
    ds_write_b32 v88, v26
    ds_write_b32 v89, v27
    ds_write2_b32 v90, v28, v29 offset1:2
    ds_write2_b32 v90, v30, v31 offset0:4 offset1:6
    s_nop 3
    ds_write2_b32 v91, v32, v33 offset1:2
    ds_write2_b32 v91, v34, v35 offset0:68 offset1:70
    s_waitcnt lgkmcnt(0)
    s_barrier
    ds_read_b64 v[160:161], v64
    ds_read_b64 v[162:163], v65
    ds_read_b64 v[164:165], v66
    ds_read_b64 v[166:167], v67
    ds_read_b64 v[168:169], v68
    ds_read_b64 v[170:171], v69
    ds_read_b64 v[172:173], v70
    ds_read_b64 v[174:175], v71
    ds_read_b64 v[176:177], v72
    ds_read_b64 v[178:179], v73
    ds_read_b64 v[180:181], v74
    s_add_u32 s38, s36, 352256
    s_addc_u32 s39, s37, 0
    global_load_dword a56, v248, s[38:39] offset:-2752
    global_load_dword a57, v248, s[38:39] offset:0
    ds_read_b64 v[182:183], v75
    ds_read_b64 v[184:185], v76
    ds_read_b64 v[186:187], v77
    ds_read_b64 v[188:189], v78
    ds_read_b64 v[190:191], v79
    ds_read_b64 v[192:193], v80
    ds_read_b64 v[194:195], v81
    ds_read_b64 v[196:197], v82
    ds_read_b64 v[198:199], v83
    ds_read_b64 v[200:201], v84
    ds_read_b64 v[202:203], v85
    global_load_dword a58, v248, s[38:39] offset:2752
    global_load_dword a59, v249, s[38:39] offset:-2752
    s_waitcnt lgkmcnt(15)
    v_add_f32 v160, v160, v161
    v_add_f32 v162, v162, v163
    v_add_f32 v164, v164, v165
    v_add_f32 v166, v166, v167
    v_add_f32 v168, v168, v169
    v_add_f32 v170, v170, v171
    v_add_f32 v172, v172, v173
    s_waitcnt lgkmcnt(14)
    v_add_f32 v174, v174, v175
    s_waitcnt lgkmcnt(13)
    v_add_f32 v176, v176, v177
    s_waitcnt lgkmcnt(12)
    v_add_f32 v178, v178, v179
    s_waitcnt lgkmcnt(11)
    v_add_f32 v180, v180, v181
    v_cvt_pk_bf16_f32 v144, v166, v168
    v_cvt_pk_bf16_f32 v145, v170, v172
    v_cvt_pk_bf16_f32 v146, v174, v176
    v_cvt_pk_bf16_f32 v147, v178, v180
    ds_write_b128 v93, v[144:147] offset:0
    global_load_dword a60, v249, s[38:39] offset:0
    global_load_dword a61, v249, s[38:39] offset:2752
    v_cvt_pk_bf16_f32 v148, v164, v166
    v_cvt_pk_bf16_f32 v149, v168, v170
    v_cvt_pk_bf16_f32 v150, v172, v174
    v_cvt_pk_bf16_f32 v151, v176, v178
    ds_write_b128 v93, v[148:151] offset:4160
    global_load_dword a62, v250, s[38:39] offset:-2752
    global_load_dword a63, v250, s[38:39] offset:0
    v_cvt_pk_bf16_f32 v152, v162, v164
    v_cvt_pk_bf16_f32 v153, v166, v168
    v_cvt_pk_bf16_f32 v154, v170, v172
    v_cvt_pk_bf16_f32 v155, v174, v176
    ds_write_b128 v93, v[152:155] offset:8320
    s_add_u32 s38, s34, 352256
    s_addc_u32 s39, s35, 0
    global_load_dword a64, v248, s[38:39] offset:-2752
    global_load_dword a65, v248, s[38:39] offset:0
    v_cvt_pk_bf16_f32 v156, v160, v162
    v_cvt_pk_bf16_f32 v157, v164, v166
    v_cvt_pk_bf16_f32 v158, v168, v170
    v_cvt_pk_bf16_f32 v159, v172, v174
    ds_write_b128 v93, v[156:159] offset:12480
    global_load_dword a66, v248, s[38:39] offset:2752
    global_load_dword a67, v249, s[38:39] offset:-2752
    s_waitcnt lgkmcnt(14)
    v_add_f32 v182, v182, v183
    s_waitcnt lgkmcnt(13)
    v_add_f32 v184, v184, v185
    s_waitcnt lgkmcnt(12)
    v_add_f32 v186, v186, v187
    s_waitcnt lgkmcnt(11)
    v_add_f32 v188, v188, v189
    s_waitcnt lgkmcnt(10)
    v_add_f32 v190, v190, v191
    s_waitcnt lgkmcnt(9)
    v_add_f32 v192, v192, v193
    s_waitcnt lgkmcnt(8)
    v_add_f32 v194, v194, v195
    s_waitcnt lgkmcnt(7)
    v_add_f32 v196, v196, v197
    s_waitcnt lgkmcnt(6)
    v_add_f32 v198, v198, v199
    s_waitcnt lgkmcnt(5)
    v_add_f32 v200, v200, v201
    s_waitcnt lgkmcnt(4)
    v_add_f32 v202, v202, v203
    v_cvt_pk_bf16_f32 v144, v188, v190
    v_cvt_pk_bf16_f32 v145, v192, v194
    v_cvt_pk_bf16_f32 v146, v196, v198
    v_cvt_pk_bf16_f32 v147, v200, v202
    ds_write_b128 v93, v[144:147] offset:2048
    global_load_dword a68, v249, s[38:39] offset:0
    global_load_dword a69, v249, s[38:39] offset:2752
    v_cvt_pk_bf16_f32 v148, v186, v188
    v_cvt_pk_bf16_f32 v149, v190, v192
    v_cvt_pk_bf16_f32 v150, v194, v196
    v_cvt_pk_bf16_f32 v151, v198, v200
    ds_write_b128 v93, v[148:151] offset:6208
    global_load_dword a70, v250, s[38:39] offset:-2752
    global_load_dword a71, v250, s[38:39] offset:0
    v_cvt_pk_bf16_f32 v152, v184, v186
    v_cvt_pk_bf16_f32 v153, v188, v190
    v_cvt_pk_bf16_f32 v154, v192, v194
    v_cvt_pk_bf16_f32 v155, v196, v198
    ds_write_b128 v93, v[152:155] offset:10368
    s_add_u32 s38, s32, 528384
    s_addc_u32 s39, s33, 0
    global_load_dword a72, v248, s[38:39] offset:-2752
    global_load_dword a73, v248, s[38:39] offset:0
    v_cvt_pk_bf16_f32 v156, v182, v184
    v_cvt_pk_bf16_f32 v157, v186, v188
    v_cvt_pk_bf16_f32 v158, v190, v192
    v_cvt_pk_bf16_f32 v159, v194, v196
    ds_write_b128 v93, v[156:159] offset:14528
    global_load_dword a74, v248, s[38:39] offset:2752
    global_load_dword a75, v249, s[38:39] offset:-2752
    s_waitcnt vmcnt(63)
    v_readfirstlane_b32 s57, v17
    s_lshl_b32 s60, s53, 4
    s_lshr_b32 s57, s57, s60
    s_and_b32 s57, s57, 0xffff
    v_and_b32 v24, 15, v1
    v_bfe_u32 v25, v1, 4, 1
    v_lshlrev_b32 v25, 3, v25
    v_sub_u32 v24, v24, v25
    v_mov_b32 v25, s57
    v_mov_b32 v26, 0x3f80
    v_cmp_gt_u32 vcc, 32, v1
    s_nop 1
    v_cndmask_b32 v25, v25, v26, vcc
    v_and_b32 v26, 1, v24
    v_lshlrev_b32 v26, 4, v26
    v_lshlrev_b32 v25, v26, v25
    v_ashrrev_i32 v24, 1, v24
    v_cmp_eq_u32 vcc, 0, v24
    s_nop 1
    v_cndmask_b32 v104, 0, v25, vcc
    v_cmp_eq_u32 vcc, 1, v24
    s_nop 1
    v_cndmask_b32 v105, 0, v25, vcc
    v_cmp_eq_u32 vcc, 2, v24
    s_nop 1
    v_cndmask_b32 v106, 0, v25, vcc
    v_cmp_eq_u32 vcc, 3, v24
    s_nop 1
    v_cndmask_b32 v107, 0, v25, vcc
    s_mov_b32 s69, 0
S1_CHK:
    s_waitcnt vmcnt(20)
    v_xor_b32 v24, s55, v98
    v_bitop3_b32 v24, v24, v223, s55 bitop3:0xf6
    v_bitop3_b32 v24, v24, v227, s55 bitop3:0xf6
    v_bitop3_b32 v24, v24, v231, s55 bitop3:0xf6
    v_bitop3_b32 v24, v24, v235, s55 bitop3:0xf6
    v_bitop3_b32 v24, v24, v239, s55 bitop3:0xf6
    v_bitop3_b32 v24, v24, v243, s55 bitop3:0xf6
    v_bitop3_b32 v24, v24, v247, s55 bitop3:0xf6
    v_cmp_lt_u32 vcc, 7, v24
    s_cbranch_vccnz S1_RETRY
S1_OK:
    v_cmp_ne_u32 s[48:49], s68, v98
    s_nop 0
    s_cmp_lg_u64 s[48:49], 0
    s_cbranch_scc1 CLR_X
    s_mov_b32 s60, 0
    buffer_store_dwordx4 v[108:111], v128, s[44:47], s60 offen
    s_mov_b32 s60, 45056
    buffer_store_dwordx4 v[108:111], v128, s[44:47], s60 offen
    s_mov_b32 s60, 90112
    buffer_store_dwordx4 v[108:111], v128, s[44:47], s60 offen
    s_mov_b32 s60, 135168
    buffer_store_dwordx4 v[108:111], v128, s[44:47], s60 offen
    s_mov_b32 s60, 0
    buffer_store_dwordx4 v[108:111], v218, s[44:47], s60 offen
    s_mov_b32 s60, 45056
    buffer_store_dwordx4 v[108:111], v218, s[44:47], s60 offen
CLR_D:
    global_load_ubyte v253, v127, s[76:77]
    s_mov_b32 s60, 0x05040100
    s_mov_b32 s61, 0x07060302
    v_lshlrev_b32 v235, 16, v234
    v_and_b32 v234, 0xffff0000, v234
    v_lshlrev_b32 v88, 16, v220
    v_lshlrev_b32 v89, 16, v221
    v_mul_f32 v235, -v235, v232
    v_mul_f32 v234, -v234, v233
    global_load_dword a76, v249, s[38:39] offset:0
    v_and_b32 v90, 0xffff0000, v220
    v_and_b32 v91, 0xffff0000, v221
    v_fma_f32 v88, v88, v232, v235
    v_fma_f32 v89, v89, v233, v234
    v_fma_f32 v90, v90, v232, v235
    v_fma_f32 v91, v91, v233, v234
    global_load_dword a77, v249, s[38:39] offset:2752
    v_cvt_pk_bf16_f32 v56, v88, v89
    v_cvt_pk_bf16_f32 v60, v90, v91
    v_lshlrev_b32 v239, 16, v238
    v_and_b32 v238, 0xffff0000, v238
    v_lshlrev_b32 v92, 16, v222
    v_lshlrev_b32 v93, 16, v224
    global_load_dword a78, v250, s[38:39] offset:-2752
    v_mul_f32 v239, -v239, v236
    v_mul_f32 v238, -v238, v237
    v_and_b32 v94, 0xffff0000, v222
    v_and_b32 v95, 0xffff0000, v224
    v_fma_f32 v92, v92, v236, v239
    global_load_dword a79, v250, s[38:39] offset:0
    v_fma_f32 v93, v93, v237, v238
    v_fma_f32 v94, v94, v236, v239
    v_fma_f32 v95, v95, v237, v238
    v_cvt_pk_bf16_f32 v57, v92, v93
    v_cvt_pk_bf16_f32 v61, v94, v95
    v_lshlrev_b32 v243, 16, v242
    s_add_u32 s38, s36, 528384
    s_addc_u32 s39, s37, 0
    global_load_dword a80, v248, s[38:39] offset:-2752
    v_and_b32 v242, 0xffff0000, v242
    v_lshlrev_b32 v96, 16, v225
    v_lshlrev_b32 v97, 16, v226
    v_mul_f32 v243, -v243, v240
    v_mul_f32 v242, -v242, v241
    v_and_b32 v98, 0xffff0000, v225
    global_load_dword a81, v248, s[38:39] offset:0
    v_and_b32 v99, 0xffff0000, v226
    v_fma_f32 v96, v96, v240, v243
    v_fma_f32 v97, v97, v241, v242
    v_fma_f32 v98, v98, v240, v243
    v_fma_f32 v99, v99, v241, v242
    v_cvt_pk_bf16_f32 v58, v96, v97
    global_load_dword a82, v248, s[38:39] offset:2752
    v_cvt_pk_bf16_f32 v62, v98, v99
    v_lshlrev_b32 v247, 16, v246
    v_and_b32 v246, 0xffff0000, v246
    v_lshlrev_b32 v100, 16, v228
    v_lshlrev_b32 v101, 16, v229
    global_load_dword a83, v249, s[38:39] offset:-2752
    v_mul_f32 v247, -v247, v244
    v_mul_f32 v246, -v246, v245
    v_and_b32 v102, 0xffff0000, v228
    v_and_b32 v103, 0xffff0000, v229
    v_fma_f32 v100, v100, v244, v247
    v_fma_f32 v101, v101, v245, v246
    global_load_dword a84, v249, s[38:39] offset:0
    v_fma_f32 v102, v102, v244, v247
    v_fma_f32 v103, v103, v245, v246
    v_cvt_pk_bf16_f32 v59, v100, v101
    v_cvt_pk_bf16_f32 v63, v102, v103
    v_add_u32 v72, 0xffffde20, v217
    ds_write_b128 v72, v[56:59]
    global_load_dword a85, v249, s[38:39] offset:2752
    ds_write_b128 v72, v[60:63] offset:4576
    v_perm_b32 v64, v221, v220, s60
    v_perm_b32 v65, v224, v222, s60
    v_perm_b32 v66, v226, v225, s60
    v_perm_b32 v67, v229, v228, s60
    ds_write_b128 v217, v[64:67] offset:0
    global_load_dword a86, v250, s[38:39] offset:-2752
    v_perm_b32 v68, v221, v220, s61
    v_perm_b32 v69, v224, v222, s61
    v_perm_b32 v70, v226, v225, s61
    v_perm_b32 v71, v229, v228, s61
    ds_write_b128 v217, v[68:71] offset:4096
    global_load_dword a87, v250, s[38:39] offset:0
    s_waitcnt lgkmcnt(0)
    s_barrier
    s_or_b32 s60, s2, s3
    s_cbranch_scc0 EP_BUMP
EP_DONE:
    ds_read_b64 v[176:177], v208 offset:3776
    ds_read_b64 v[178:179], v208 offset:3784
    ds_read_b128 v[56:59], v212 offset:192
    ds_read_b128 v[60:63], v212 offset:704
    s_add_u32 s38, s34, 528384
    s_addc_u32 s39, s35, 0
    global_load_dword a88, v248, s[38:39] offset:-2752
    ds_read_b128 v[64:67], v212 offset:1216
    global_load_dword a89, v248, s[38:39] offset:0
    ds_read_b128 v[68:71], v212 offset:1728
    ds_read_b128 v[72:75], v212 offset:2240
    global_load_dword a90, v248, s[38:39] offset:2752
    ds_read_b128 v[76:79], v212 offset:2752
    global_load_dword a91, v249, s[38:39] offset:-2752
    ds_read_b128 v[80:83], v212 offset:3264
    ds_read_b128 v[84:87], v212 offset:3776
    global_load_dword a92, v249, s[38:39] offset:0
    ds_read_b64 v[180:181], v208 offset:192
    ds_read_b64 v[182:183], v208 offset:200
    ds_read_b64 v[184:185], v208 offset:3264
    ds_read_b64 v[186:187], v208 offset:3272
    ds_read_b64 v[188:189], v208 offset:704
    ds_read_b64 v[190:191], v208 offset:712
    global_load_dword a93, v249, s[38:39] offset:2752
    s_waitcnt lgkmcnt(13)
    v_mfma_f32_16x16x32_bf16 v[24:27], v[176:179], v[56:59], 0
    ds_read_b64 v[192:193], v208 offset:2752
    global_load_dword a94, v250, s[38:39] offset:-2752
    s_waitcnt lgkmcnt(13)
    v_mfma_f32_16x16x32_bf16 v[28:31], v[176:179], v[60:63], 0
    ds_read_b64 v[194:195], v208 offset:2760
    s_branch PO_2
.p2align 12
PG_2:
    s_branch HOP_A
PO_2:
    global_load_dword a95, v250, s[38:39] offset:0
    s_waitcnt lgkmcnt(13)
    v_mfma_f32_16x16x32_bf16 v[32:35], v[176:179], v[64:67], 0
    ds_read_b64 v[196:197], v208 offset:1216
    s_waitcnt lgkmcnt(13)
    v_mfma_f32_16x16x32_bf16 v[36:39], v[176:179], v[68:71], 0
    ds_read_b64 v[198:199], v208 offset:1224
    s_add_u32 s38, s32, 704512
    s_addc_u32 s39, s33, 0
    global_load_dword a96, v248, s[38:39] offset:-2752
    s_waitcnt lgkmcnt(13)
    v_mfma_f32_16x16x32_bf16 v[40:43], v[176:179], v[72:75], 0
    ds_read_b128 v[144:147], v212 offset:128
    global_load_dword a97, v248, s[38:39] offset:0
    s_waitcnt lgkmcnt(13)
    v_mfma_f32_16x16x32_bf16 v[44:47], v[176:179], v[76:79], 0
    ds_read_b128 v[148:151], v212 offset:640
    s_waitcnt lgkmcnt(13)
    v_mfma_f32_16x16x32_bf16 v[48:51], v[176:179], v[80:83], 0
    ds_read_b128 v[152:155], v212 offset:1152
    global_load_dword a98, v248, s[38:39] offset:2752
    s_waitcnt lgkmcnt(13)
    v_mfma_f32_16x16x32_bf16 v[52:55], v[176:179], v[84:87], 0
    global_load_dword a99, v249, s[38:39] offset:-2752
    s_waitcnt lgkmcnt(11)
    v_mfma_f32_16x16x32_bf16 v[52:55], v[180:183], v[56:59], v[52:55]
    s_waitcnt lgkmcnt(7)
    v_mfma_f32_16x16x32_bf16 v[28:31], v[184:187], v[56:59], v[28:31]
    ds_read_b64 v[176:177], v208 offset:1728
    global_load_dword a100, v249, s[38:39] offset:0
    v_mfma_f32_16x16x32_bf16 v[32:35], v[184:187], v[60:63], v[32:35]
    ds_read_b64 v[178:179], v208 offset:1736
    global_load_dword a101, v249, s[38:39] offset:2752
    v_mfma_f32_16x16x32_bf16 v[36:39], v[184:187], v[64:67], v[36:39]
    ds_read_b64 v[180:181], v208 offset:2240
    v_mfma_f32_16x16x32_bf16 v[40:43], v[184:187], v[68:71], v[40:43]
    ds_read_b64 v[182:183], v208 offset:2248
    global_load_dword a102, v250, s[38:39] offset:-2752
    v_mfma_f32_16x16x32_bf16 v[44:47], v[184:187], v[72:75], v[44:47]
    ds_read_b128 v[156:159], v212 offset:1664
    global_load_dword a103, v250, s[38:39] offset:0
    v_mfma_f32_16x16x32_bf16 v[48:51], v[184:187], v[76:79], v[48:51]
    ds_read_b128 v[160:163], v212 offset:2176
    v_mfma_f32_16x16x32_bf16 v[52:55], v[184:187], v[80:83], v[52:55]
    ds_read_b128 v[164:167], v212 offset:2688
    s_add_u32 s38, s36, 704512
    s_addc_u32 s39, s37, 0
    global_load_dword a104, v248, s[38:39] offset:-2752
    v_mfma_f32_16x16x32_bf16 v[48:51], v[188:191], v[56:59], v[48:51]
    global_load_dword a105, v248, s[38:39] offset:0
    v_mfma_f32_16x16x32_bf16 v[52:55], v[188:191], v[60:63], v[52:55]
    s_waitcnt lgkmcnt(10)
    v_mfma_f32_16x16x32_bf16 v[32:35], v[192:195], v[56:59], v[32:35]
    ds_read_b64 v[184:185], v208 offset:3712
    global_load_dword a106, v248, s[38:39] offset:2752
    v_mfma_f32_16x16x32_bf16 v[36:39], v[192:195], v[60:63], v[36:39]
    ds_read_b64 v[186:187], v208 offset:3720
    global_load_dword a107, v249, s[38:39] offset:-2752
    v_mfma_f32_16x16x32_bf16 v[40:43], v[192:195], v[64:67], v[40:43]
    ds_read_b64 v[188:189], v208 offset:128
    v_mfma_f32_16x16x32_bf16 v[44:47], v[192:195], v[68:71], v[44:47]
    ds_read_b64 v[190:191], v208 offset:136
    global_load_dword a108, v249, s[38:39] offset:0
    v_mfma_f32_16x16x32_bf16 v[48:51], v[192:195], v[72:75], v[48:51]
    ds_read_b128 v[168:171], v212 offset:3200
    global_load_dword a109, v249, s[38:39] offset:2752
    v_mfma_f32_16x16x32_bf16 v[52:55], v[192:195], v[76:79], v[52:55]
    ds_read_b128 v[172:175], v212 offset:3712
    v_mfma_f32_16x16x32_bf16 v[44:47], v[196:199], v[56:59], v[44:47]
    global_load_dword a110, v250, s[38:39] offset:-2752
    v_mfma_f32_16x16x32_bf16 v[48:51], v[196:199], v[60:63], v[48:51]
    global_load_dword a111, v250, s[38:39] offset:0
    v_mfma_f32_16x16x32_bf16 v[52:55], v[196:199], v[64:67], v[52:55]
    s_waitcnt lgkmcnt(9)
    v_mfma_f32_16x16x32_bf16 v[40:43], v[176:179], v[56:59], v[40:43]
    ds_read_b64 v[192:193], v208 offset:3200
    s_add_u32 s38, s34, 704512
    s_addc_u32 s39, s35, 0
    global_load_dword a112, v248, s[38:39] offset:-2752
    v_mfma_f32_16x16x32_bf16 v[44:47], v[176:179], v[60:63], v[44:47]
    ds_read_b64 v[194:195], v208 offset:3208
    global_load_dword a113, v248, s[38:39] offset:0
    v_mfma_f32_16x16x32_bf16 v[48:51], v[176:179], v[64:67], v[48:51]
    ds_read_b64 v[196:197], v208 offset:640
    global_load_dword a114, v248, s[38:39] offset:2752
    v_mfma_f32_16x16x32_bf16 v[52:55], v[176:179], v[68:71], v[52:55]
    ds_read_b64 v[198:199], v208 offset:648
    v_mfma_f32_16x16x32_bf16 v[40:43], v[180:183], v[60:63], v[40:43]
    global_load_dword a115, v249, s[38:39] offset:-2752
    v_mfma_f32_16x16x32_bf16 v[44:47], v[180:183], v[64:67], v[44:47]
    global_load_dword a116, v249, s[38:39] offset:0
    v_mfma_f32_16x16x32_bf16 v[48:51], v[180:183], v[68:71], v[48:51]
    v_mfma_f32_16x16x32_bf16 v[52:55], v[180:183], v[72:75], v[52:55]
    global_load_dword a117, v249, s[38:39] offset:2752
    v_mfma_f32_16x16x32_bf16 v[36:39], v[180:183], v[56:59], v[36:39]
    s_waitcnt lgkmcnt(4)
    global_load_dword a118, v250, s[38:39] offset:-2752
    v_mfma_f32_16x16x32_bf16 v[24:27], v[184:187], v[144:147], v[24:27]
    ds_read_b64 v[176:177], v208 offset:2688
    v_mfma_f32_16x16x32_bf16 v[28:31], v[184:187], v[148:151], v[28:31]
    ds_read_b64 v[178:179], v208 offset:2696
    global_load_dword a119, v250, s[38:39] offset:0
    v_mfma_f32_16x16x32_bf16 v[32:35], v[184:187], v[152:155], v[32:35]
    ds_read_b64 v[180:181], v208 offset:1152
    s_add_u32 s38, s32, 880640
    s_addc_u32 s39, s33, 0
    global_load_dword a120, v248, s[38:39] offset:-2752
    v_mfma_f32_16x16x32_bf16 v[36:39], v[184:187], v[156:159], v[36:39]
    ds_read_b64 v[182:183], v208 offset:1160
    v_mfma_f32_16x16x32_bf16 v[40:43], v[184:187], v[160:163], v[40:43]
    ds_read_b128 v[56:59], v212 offset:64
    global_load_dword a121, v248, s[38:39] offset:0
    v_mfma_f32_16x16x32_bf16 v[44:47], v[184:187], v[164:167], v[44:47]
    ds_read_b128 v[60:63], v212 offset:576
    global_load_dword a122, v248, s[38:39] offset:2752
    v_mfma_f32_16x16x32_bf16 v[48:51], v[184:187], v[168:171], v[48:51]
    ds_read_b128 v[64:67], v212 offset:1088
    v_mfma_f32_16x16x32_bf16 v[52:55], v[184:187], v[172:175], v[52:55]
    global_load_dword a123, v249, s[38:39] offset:-2752
    v_mfma_f32_16x16x32_bf16 v[52:55], v[188:191], v[144:147], v[52:55]
    s_waitcnt lgkmcnt(7)
    global_load_dword a124, v249, s[38:39] offset:0
    v_mfma_f32_16x16x32_bf16 v[28:31], v[192:195], v[144:147], v[28:31]
    ds_read_b64 v[184:185], v208 offset:1664
    v_mfma_f32_16x16x32_bf16 v[32:35], v[192:195], v[148:151], v[32:35]
    ds_read_b64 v[186:187], v208 offset:1672
    global_load_dword a125, v249, s[38:39] offset:2752
    v_mfma_f32_16x16x32_bf16 v[36:39], v[192:195], v[152:155], v[36:39]
    ds_read_b64 v[188:189], v208 offset:2176
    global_load_dword a126, v250, s[38:39] offset:-2752
    v_mfma_f32_16x16x32_bf16 v[40:43], v[192:195], v[156:159], v[40:43]
    ds_read_b64 v[190:191], v208 offset:2184
    v_mfma_f32_16x16x32_bf16 v[44:47], v[192:195], v[160:163], v[44:47]
    ds_read_b128 v[68:71], v212 offset:1600
    global_load_dword a127, v250, s[38:39] offset:0
    v_mfma_f32_16x16x32_bf16 v[48:51], v[192:195], v[164:167], v[48:51]
    ds_read_b128 v[72:75], v212 offset:2112
    s_add_u32 s38, s36, 880640
    s_addc_u32 s39, s37, 0
    global_load_dword a128, v248, s[38:39] offset:-2752
    v_mfma_f32_16x16x32_bf16 v[52:55], v[192:195], v[168:171], v[52:55]
    ds_read_b128 v[76:79], v212 offset:2624
    v_mfma_f32_16x16x32_bf16 v[48:51], v[196:199], v[144:147], v[48:51]
    global_load_dword a129, v248, s[38:39] offset:0
    v_mfma_f32_16x16x32_bf16 v[52:55], v[196:199], v[148:151], v[52:55]
    s_waitcnt lgkmcnt(10)
    global_load_dword a130, v248, s[38:39] offset:2752
    v_mfma_f32_16x16x32_bf16 v[32:35], v[176:179], v[144:147], v[32:35]
    ds_read_b64 v[192:193], v208 offset:3648
    v_mfma_f32_16x16x32_bf16 v[36:39], v[176:179], v[148:151], v[36:39]
    ds_read_b64 v[194:195], v208 offset:3656
    global_load_dword a131, v249, s[38:39] offset:-2752
    v_mfma_f32_16x16x32_bf16 v[40:43], v[176:179], v[152:155], v[40:43]
    ds_read_b64 v[196:197], v208 offset:64
    global_load_dword a132, v249, s[38:39] offset:0
    v_mfma_f32_16x16x32_bf16 v[44:47], v[176:179], v[156:159], v[44:47]
    ds_read_b64 v[198:199], v208 offset:72
    v_mfma_f32_16x16x32_bf16 v[48:51], v[176:179], v[160:163], v[48:51]
    ds_read_b128 v[80:83], v212 offset:3136
    global_load_dword a133, v249, s[38:39] offset:2752
    v_mfma_f32_16x16x32_bf16 v[52:55], v[176:179], v[164:167], v[52:55]
    ds_read_b128 v[84:87], v212 offset:3648
    global_load_dword a134, v250, s[38:39] offset:-2752
    v_mfma_f32_16x16x32_bf16 v[44:47], v[180:183], v[144:147], v[44:47]
    v_mfma_f32_16x16x32_bf16 v[48:51], v[180:183], v[148:151], v[48:51]
    global_load_dword a135, v250, s[38:39] offset:0
    v_mfma_f32_16x16x32_bf16 v[52:55], v[180:183], v[152:155], v[52:55]
    s_waitcnt lgkmcnt(9)
    s_add_u32 s38, s34, 880640
    s_addc_u32 s39, s35, 0
    global_load_dword a136, v248, s[38:39] offset:-2752
    v_mfma_f32_16x16x32_bf16 v[40:43], v[184:187], v[144:147], v[40:43]
    ds_read_b64 v[176:177], v208 offset:3136
    v_mfma_f32_16x16x32_bf16 v[44:47], v[184:187], v[148:151], v[44:47]
    ds_read_b64 v[178:179], v208 offset:3144
    global_load_dword a137, v248, s[38:39] offset:0
    v_mfma_f32_16x16x32_bf16 v[48:51], v[184:187], v[152:155], v[48:51]
    ds_read_b64 v[180:181], v208 offset:576
    global_load_dword a138, v248, s[38:39] offset:2752
    v_mfma_f32_16x16x32_bf16 v[52:55], v[184:187], v[156:159], v[52:55]
    ds_read_b64 v[182:183], v208 offset:584
    global_load_dword a139, v249, s[38:39] offset:-2752
    v_mfma_f32_16x16x32_bf16 v[40:43], v[188:191], v[148:151], v[40:43]
    v_mfma_f32_16x16x32_bf16 v[44:47], v[188:191], v[152:155], v[44:47]
    global_load_dword a140, v249, s[38:39] offset:0
    v_mfma_f32_16x16x32_bf16 v[48:51], v[188:191], v[156:159], v[48:51]
    global_load_dword a141, v249, s[38:39] offset:2752
    v_mfma_f32_16x16x32_bf16 v[52:55], v[188:191], v[160:163], v[52:55]
    v_mfma_f32_16x16x32_bf16 v[36:39], v[188:191], v[144:147], v[36:39]
    s_waitcnt lgkmcnt(4)
    global_load_dword a142, v250, s[38:39] offset:-2752
    v_mfma_f32_16x16x32_bf16 v[24:27], v[192:195], v[56:59], v[24:27]
    ds_read_b64 v[184:185], v208 offset:2624
    global_load_dword a143, v250, s[38:39] offset:0
    v_mfma_f32_16x16x32_bf16 v[28:31], v[192:195], v[60:63], v[28:31]
    ds_read_b64 v[186:187], v208 offset:2632
    v_mfma_f32_16x16x32_bf16 v[32:35], v[192:195], v[64:67], v[32:35]
    ds_read_b64 v[188:189], v208 offset:1088
    s_add_u32 s38, s32, 1056768
    s_addc_u32 s39, s33, 0
    global_load_dword a144, v248, s[38:39] offset:-2752
    v_mfma_f32_16x16x32_bf16 v[36:39], v[192:195], v[68:71], v[36:39]
    ds_read_b64 v[190:191], v208 offset:1096
    global_load_dword a145, v248, s[38:39] offset:0
    v_mfma_f32_16x16x32_bf16 v[40:43], v[192:195], v[72:75], v[40:43]
    ds_read_b128 v[144:147], v212 offset:0
    v_mfma_f32_16x16x32_bf16 v[44:47], v[192:195], v[76:79], v[44:47]
    ds_read_b128 v[148:151], v212 offset:512
    global_load_dword a146, v248, s[38:39] offset:2752
    v_mfma_f32_16x16x32_bf16 v[48:51], v[192:195], v[80:83], v[48:51]
    ds_read_b128 v[152:155], v212 offset:1024
    global_load_dword a147, v249, s[38:39] offset:-2752
    v_mfma_f32_16x16x32_bf16 v[52:55], v[192:195], v[84:87], v[52:55]
    v_mfma_f32_16x16x32_bf16 v[52:55], v[196:199], v[56:59], v[52:55]
    s_waitcnt lgkmcnt(7)
    global_load_dword a148, v249, s[38:39] offset:0
    v_mfma_f32_16x16x32_bf16 v[28:31], v[176:179], v[56:59], v[28:31]
    ds_read_b64 v[192:193], v208 offset:1600
    global_load_dword a149, v249, s[38:39] offset:2752
    v_mfma_f32_16x16x32_bf16 v[32:35], v[176:179], v[60:63], v[32:35]
    ds_read_b64 v[194:195], v208 offset:1608
    v_mfma_f32_16x16x32_bf16 v[36:39], v[176:179], v[64:67], v[36:39]
    ds_read_b64 v[196:197], v208 offset:2112
    global_load_dword a150, v250, s[38:39] offset:-2752
    v_mfma_f32_16x16x32_bf16 v[40:43], v[176:179], v[68:71], v[40:43]
    ds_read_b64 v[198:199], v208 offset:2120
    global_load_dword a151, v250, s[38:39] offset:0
    v_mfma_f32_16x16x32_bf16 v[44:47], v[176:179], v[72:75], v[44:47]
    ds_read_b128 v[156:159], v212 offset:1536
    v_mfma_f32_16x16x32_bf16 v[48:51], v[176:179], v[76:79], v[48:51]
    ds_read_b128 v[160:163], v212 offset:2048
    s_add_u32 s38, s36, 1056768
    s_addc_u32 s39, s37, 0
    global_load_dword a152, v248, s[38:39] offset:-2752
    v_mfma_f32_16x16x32_bf16 v[52:55], v[176:179], v[80:83], v[52:55]
    ds_read_b128 v[164:167], v212 offset:2560
    global_load_dword a153, v248, s[38:39] offset:0
    v_mfma_f32_16x16x32_bf16 v[48:51], v[180:183], v[56:59], v[48:51]
    v_mfma_f32_16x16x32_bf16 v[52:55], v[180:183], v[60:63], v[52:55]
    s_waitcnt lgkmcnt(10)
    global_load_dword a154, v248, s[38:39] offset:2752
    v_mfma_f32_16x16x32_bf16 v[32:35], v[184:187], v[56:59], v[32:35]
    ds_read_b64 v[176:177], v208 offset:3584
    global_load_dword a155, v249, s[38:39] offset:-2752
    v_mfma_f32_16x16x32_bf16 v[36:39], v[184:187], v[60:63], v[36:39]
    ds_read_b64 v[178:179], v208 offset:3592
    v_mfma_f32_16x16x32_bf16 v[40:43], v[184:187], v[64:67], v[40:43]
    ds_read_b64 v[180:181], v208 offset:0
    global_load_dword a156, v249, s[38:39] offset:0
    v_mfma_f32_16x16x32_bf16 v[44:47], v[184:187], v[68:71], v[44:47]
    ds_read_b64 v[182:183], v208 offset:8
    global_load_dword a157, v249, s[38:39] offset:2752
    v_mfma_f32_16x16x32_bf16 v[48:51], v[184:187], v[72:75], v[48:51]
    ds_read_b128 v[168:171], v212 offset:3072
    v_mfma_f32_16x16x32_bf16 v[52:55], v[184:187], v[76:79], v[52:55]
    ds_read_b128 v[172:175], v212 offset:3584
    global_load_dword a158, v250, s[38:39] offset:-2752
    v_mfma_f32_16x16x32_bf16 v[44:47], v[188:191], v[56:59], v[44:47]
    global_load_dword a159, v250, s[38:39] offset:0
    v_mfma_f32_16x16x32_bf16 v[48:51], v[188:191], v[60:63], v[48:51]
    v_mfma_f32_16x16x32_bf16 v[52:55], v[188:191], v[64:67], v[52:55]
    s_waitcnt lgkmcnt(9)
    s_add_u32 s38, s34, 1056768
    s_addc_u32 s39, s35, 0
    global_load_dword a160, v248, s[38:39] offset:-2752
    v_mfma_f32_16x16x32_bf16 v[40:43], v[192:195], v[56:59], v[40:43]
    ds_read_b64 v[184:185], v208 offset:3072
    global_load_dword a161, v248, s[38:39] offset:0
    v_mfma_f32_16x16x32_bf16 v[44:47], v[192:195], v[60:63], v[44:47]
    ds_read_b64 v[186:187], v208 offset:3080
    v_mfma_f32_16x16x32_bf16 v[48:51], v[192:195], v[64:67], v[48:51]
    ds_read_b64 v[188:189], v208 offset:512
    global_load_dword a162, v248, s[38:39] offset:2752
    v_mfma_f32_16x16x32_bf16 v[52:55], v[192:195], v[68:71], v[52:55]
    ds_read_b64 v[190:191], v208 offset:520
    global_load_dword a163, v249, s[38:39] offset:-2752
    v_mfma_f32_16x16x32_bf16 v[40:43], v[196:199], v[60:63], v[40:43]
    v_mfma_f32_16x16x32_bf16 v[44:47], v[196:199], v[64:67], v[44:47]
    global_load_dword a164, v249, s[38:39] offset:0
    v_mfma_f32_16x16x32_bf16 v[48:51], v[196:199], v[68:71], v[48:51]
    global_load_dword a165, v249, s[38:39] offset:2752
    v_mfma_f32_16x16x32_bf16 v[52:55], v[196:199], v[72:75], v[52:55]
    global_load_dword a166, v250, s[38:39] offset:-2752
    v_mfma_f32_16x16x32_bf16 v[36:39], v[196:199], v[56:59], v[36:39]
    s_waitcnt lgkmcnt(4)
    v_mfma_f32_16x16x32_bf16 v[24:27], v[176:179], v[144:147], v[24:27]
    ds_read_b64 v[192:193], v208 offset:2560
    global_load_dword a167, v250, s[38:39] offset:0
    v_mfma_f32_16x16x32_bf16 v[28:31], v[176:179], v[148:151], v[28:31]
    ds_read_b64 v[194:195], v208 offset:2568
    s_add_u32 s38, s32, 1232896
    s_addc_u32 s39, s33, 0
    global_load_dword a168, v248, s[38:39] offset:-2752
    global_load_ubyte v253, v129, s[76:77]
    v_mfma_f32_16x16x32_bf16 v[32:35], v[176:179], v[152:155], v[32:35]
    ds_read_b64 v[196:197], v208 offset:1024
    v_mfma_f32_16x16x32_bf16 v[36:39], v[176:179], v[156:159], v[36:39]
    ds_read_b64 v[198:199], v208 offset:1032
    global_load_dword a169, v248, s[38:39] offset:0
    v_mfma_f32_16x16x32_bf16 v[40:43], v[176:179], v[160:163], v[40:43]
    ds_read_b128 v[56:59], v213 offset:0
    global_load_dword a170, v248, s[38:39] offset:2752
    v_mfma_f32_16x16x32_bf16 v[44:47], v[176:179], v[164:167], v[44:47]
    ds_read_b128 v[60:63], v213 offset:512
    v_mfma_f32_16x16x32_bf16 v[48:51], v[176:179], v[168:171], v[48:51]
    global_load_dword a171, v249, s[38:39] offset:-2752
    v_mfma_f32_16x16x32_bf16 v[52:55], v[176:179], v[172:175], v[52:55]
    global_load_dword a172, v249, s[38:39] offset:0
    v_mfma_f32_16x16x32_bf16 v[52:55], v[180:183], v[144:147], v[52:55]
    s_waitcnt lgkmcnt(6)
    v_mfma_f32_16x16x32_bf16 v[28:31], v[184:187], v[144:147], v[28:31]
    ds_read_b64 v[176:177], v208 offset:1536
    global_load_dword a173, v249, s[38:39] offset:2752
    v_mfma_f32_16x16x32_bf16 v[32:35], v[184:187], v[148:151], v[32:35]
    ds_read_b64 v[178:179], v208 offset:1544
    global_load_dword a174, v250, s[38:39] offset:-2752
    v_mfma_f32_16x16x32_bf16 v[36:39], v[184:187], v[152:155], v[36:39]
    ds_read_b64 v[180:181], v208 offset:2048
    v_mfma_f32_16x16x32_bf16 v[40:43], v[184:187], v[156:159], v[40:43]
    ds_read_b64 v[182:183], v208 offset:2056
    global_load_dword a175, v250, s[38:39] offset:0
    v_mfma_f32_16x16x32_bf16 v[44:47], v[184:187], v[160:163], v[44:47]
    ds_read_b128 v[64:67], v213 offset:1024
    s_add_u32 s38, s36, 1232896
    s_addc_u32 s39, s37, 0
    global_load_dword a176, v248, s[38:39] offset:-2752
    v_mfma_f32_16x16x32_bf16 v[48:51], v[184:187], v[164:167], v[48:51]
    ds_read_b128 v[68:71], v213 offset:1536
    v_mfma_f32_16x16x32_bf16 v[52:55], v[184:187], v[168:171], v[52:55]
    global_load_dword a177, v248, s[38:39] offset:0
    v_mfma_f32_16x16x32_bf16 v[48:51], v[188:191], v[144:147], v[48:51]
    global_load_dword a178, v248, s[38:39] offset:2752
    v_mfma_f32_16x16x32_bf16 v[52:55], v[188:191], v[148:151], v[52:55]
    s_waitcnt lgkmcnt(8)
    v_mfma_f32_16x16x32_bf16 v[32:35], v[192:195], v[144:147], v[32:35]
    global_load_dword a179, v249, s[38:39] offset:-2752
    v_mfma_f32_16x16x32_bf16 v[36:39], v[192:195], v[148:151], v[36:39]
    global_load_dword a180, v249, s[38:39] offset:0
    v_mfma_f32_16x16x32_bf16 v[40:43], v[192:195], v[152:155], v[40:43]
    v_mfma_f32_16x16x32_bf16 v[44:47], v[192:195], v[156:159], v[44:47]
    global_load_dword a181, v249, s[38:39] offset:2752
    v_mfma_f32_16x16x32_bf16 v[48:51], v[192:195], v[160:163], v[48:51]
    global_load_dword a182, v250, s[38:39] offset:-2752
    v_mfma_f32_16x16x32_bf16 v[52:55], v[192:195], v[164:167], v[52:55]
    v_mfma_f32_16x16x32_bf16 v[44:47], v[196:199], v[144:147], v[44:47]
    global_load_dword a183, v250, s[38:39] offset:0
    v_mfma_f32_16x16x32_bf16 v[48:51], v[196:199], v[148:151], v[48:51]
    s_add_u32 s38, s34, 1232896
    s_addc_u32 s39, s35, 0
    global_load_dword a184, v248, s[38:39] offset:-2752
    v_mfma_f32_16x16x32_bf16 v[52:55], v[196:199], v[152:155], v[52:55]
    s_waitcnt lgkmcnt(2)
    v_mfma_f32_16x16x32_bf16 v[40:43], v[176:179], v[144:147], v[40:43]
    global_load_dword a185, v248, s[38:39] offset:0
    v_mfma_f32_16x16x32_bf16 v[44:47], v[176:179], v[148:151], v[44:47]
    global_load_dword a186, v248, s[38:39] offset:2752
    v_mfma_f32_16x16x32_bf16 v[48:51], v[176:179], v[152:155], v[48:51]
    v_mfma_f32_16x16x32_bf16 v[52:55], v[176:179], v[156:159], v[52:55]
    global_load_dword a187, v249, s[38:39] offset:-2752
    v_mfma_f32_16x16x32_bf16 v[40:43], v[180:183], v[148:151], v[40:43]
    global_load_dword a188, v249, s[38:39] offset:0
    v_mfma_f32_16x16x32_bf16 v[44:47], v[180:183], v[152:155], v[44:47]
    v_mfma_f32_16x16x32_bf16 v[48:51], v[180:183], v[156:159], v[48:51]
    global_load_dword a189, v249, s[38:39] offset:2752
    v_mfma_f32_16x16x32_bf16 v[52:55], v[180:183], v[160:163], v[52:55]
    global_load_dword a190, v250, s[38:39] offset:-2752
    v_mfma_f32_16x16x32_bf16 v[36:39], v[180:183], v[144:147], v[36:39]
    global_load_dword a191, v250, s[38:39] offset:0
    s_waitcnt lgkmcnt(0)
    s_cmp_eq_u32 s54, 1
    s_cbranch_scc1 E1_1
    v_mfma_f32_16x16x32_bf16 v[24:27], v[104:107], v[56:59], v[24:27]
    ds_write_b128 v214, v[40:43] offset:0
    v_mfma_f32_16x16x32_bf16 v[28:31], v[104:107], v[60:63], v[28:31]
    ds_write_b128 v214, v[44:47] offset:1024
    v_mfma_f32_16x16x32_bf16 v[32:35], v[104:107], v[64:67], v[32:35]
    ds_write_b128 v214, v[48:51] offset:2048
    v_mfma_f32_16x16x32_bf16 v[36:39], v[104:107], v[68:71], v[36:39]
    ds_write_b128 v214, v[52:55] offset:3072
    s_branch E2_2
E1_1:
    v_mfma_f32_16x16x32_bf16 v[40:43], v[104:107], v[56:59], v[40:43]
    ds_write_b128 v214, v[24:27] offset:0
    v_mfma_f32_16x16x32_bf16 v[44:47], v[104:107], v[60:63], v[44:47]
    ds_write_b128 v214, v[28:31] offset:1024
    v_mfma_f32_16x16x32_bf16 v[48:51], v[104:107], v[64:67], v[48:51]
    ds_write_b128 v214, v[32:35] offset:2048
    v_mfma_f32_16x16x32_bf16 v[52:55], v[104:107], v[68:71], v[52:55]
    ds_write_b128 v214, v[36:39] offset:3072
E2_2:
    s_waitcnt lgkmcnt(0)
    s_barrier
    ds_read_b128 v[72:75], v215 offset:0
    ds_read_b128 v[76:79], v215 offset:1024
    ds_read_b128 v[80:83], v215 offset:2048
    ds_read_b128 v[84:87], v215 offset:3072
    s_lshl_b32 s60, s50, 13
    s_lshl_b32 s61, s3, 11
    s_add_u32 s60, s60, s61
    s_waitcnt lgkmcnt(0)
    s_cmp_eq_u32 s54, 1
    s_cbranch_scc1 E3_3
    v_pk_add_f32 v[72:73], v[72:73], v[24:25]
    v_pk_add_f32 v[74:75], v[74:75], v[26:27]
    v_pk_add_f32 v[76:77], v[76:77], v[28:29]
    v_pk_add_f32 v[78:79], v[78:79], v[30:31]
    v_pk_add_f32 v[80:81], v[80:81], v[32:33]
    v_pk_add_f32 v[82:83], v[82:83], v[34:35]
    v_pk_add_f32 v[84:85], v[84:85], v[36:37]
    v_pk_add_f32 v[86:87], v[86:87], v[38:39]
    s_branch E4_4
E3_3:
    v_pk_add_f32 v[72:73], v[72:73], v[40:41]
    v_pk_add_f32 v[74:75], v[74:75], v[42:43]
    v_pk_add_f32 v[76:77], v[76:77], v[44:45]
    v_pk_add_f32 v[78:79], v[78:79], v[46:47]
    v_pk_add_f32 v[80:81], v[80:81], v[48:49]
    v_pk_add_f32 v[82:83], v[82:83], v[50:51]
    v_pk_add_f32 v[84:85], v[84:85], v[52:53]
    v_pk_add_f32 v[86:87], v[86:87], v[54:55]
E4_4:
    v_cvt_pk_bf16_f32 v56, v72, v73
    v_cvt_pk_bf16_f32 v57, v74, v75
    v_cvt_pk_bf16_f32 v58, v76, v77
    v_cvt_pk_bf16_f32 v59, v78, v79
    s_nop 0
    v_permlane16_swap_b32 v56, v58
    v_permlane16_swap_b32 v57, v59
    s_waitcnt vmcnt(63)
    buffer_store_dwordx4 v[56:59], v216, s[40:43], s60 offen offset:0 sc1
    v_cvt_pk_bf16_f32 v60, v80, v81
    v_cvt_pk_bf16_f32 v61, v82, v83
    v_cvt_pk_bf16_f32 v62, v84, v85
    v_cvt_pk_bf16_f32 v63, v86, v87
    s_nop 0
    v_permlane16_swap_b32 v60, v62
    v_permlane16_swap_b32 v61, v63
    buffer_store_dwordx4 v[60:63], v216, s[40:43], s60 offen offset:1024 sc1
    v_mov_b32 v112, 0x3f803f80
    v_mov_b32 v113, 0x3f803f80
    v_mov_b32 v114, 0x3f803f80
    v_mov_b32 v115, 0x3f803f80
    v_and_b32 v126, 1, v1
    v_mul_u32_u24 v116, 0xaaaa, v126
    v_add_u32 v116, 0x4444, v116
    v_xor_b32 v127, s54, v126
    v_lshl_add_u32 v126, v127, 16, v126
    v_mul_u32_u24 v126, 0x5555, v126
    v_add_u32 v125, 0x88888888, v126
    v_mov_b64 v[96:97], 0
    v_mov_b64 v[100:101], 0
    s_nop 0
    v_smfmac_f32_16x16x64_bf16 v[96:99], v[112:115], a[0:7], v125
    s_add_u32 s38, s70, 0
    s_addc_u32 s39, s71, 0
    global_load_dword a192, v142, s[38:39] offset:-4096
    global_load_dword a193, v142, s[38:39] offset:-3072
    v_and_b32 v24, 15, v1
    v_lshrrev_b32 v25, 4, v1
    v_bfe_u32 v26, v1, 2, 2
    v_and_b32 v27, 3, v1
    v_and_b32 v28, 1, v25
    v_lshrrev_b32 v29, 1, v25
    v_lshrrev_b32 v30, 1, v26
    v_smfmac_f32_16x16x64_bf16 v[100:103], v[112:115], a[8:15], v125 abid:1
    global_load_dword a200, v143, s[38:39] offset:-4096
    global_load_dword a201, v143, s[38:39] offset:-3072
    v_lshl_add_u32 v31, v29, 2, v26
    v_lshl_add_u32 v31, v28, 4, v31
    v_lshlrev_b32 v31, 7, v31
    v_lshl_add_u32 v32, v28, 1, v30
    v_lshl_add_u32 v31, v32, 5, v31
    v_lshl_add_u32 v31, v27, 3, v31
    s_lshl_b32 s60, s54, 12
    v_smfmac_f32_16x16x64_bf16 v[96:99], v[112:115], a[16:23], v125
    global_load_dword a194, v142, s[38:39] offset:-2048
    global_load_dword a195, v142, s[38:39] offset:-1024
    v_add_u32 v2, s60, v31
    v_xor_b32 v3, 0x1000, v2
    v_xor_b32 v4, 32, v2
    v_xor_b32 v5, 32, v3
    v_xor_b32 v6, 64, v2
    v_xor_b32 v7, 64, v3
    v_xor_b32 v8, 96, v2
    v_smfmac_f32_16x16x64_bf16 v[96:99], v[112:115], a[24:31], v125
    global_load_dword a202, v143, s[38:39] offset:-2048
    global_load_dword a203, v143, s[38:39] offset:-1024
    v_xor_b32 v9, 96, v3
    s_lshl_b32 s60, s3, 5
    v_xor_b32 v117, s60, v2
    v_xor_b32 v118, s60, v3
    s_lshl_b32 s60, s53, 1
    v_or_b32 v33, s60, v28
    v_lshlrev_b32 v33, 1, v33
    v_smfmac_f32_16x16x64_bf16 v[100:103], v[112:115], a[32:39], v125 abid:1
    global_load_dword a196, v142, s[38:39] offset:0
    global_load_dword a197, v142, s[38:39] offset:1024
    v_and_b32 v34, 7, v1
    v_xor_b32 v33, v33, v34
    v_lshrrev_b32 v34, 3, v1
    v_lshlrev_b32 v34, 12, v34
    v_lshl_add_u32 v33, v33, 4, v34
    s_lshl_b32 s60, s51, 7
    s_lshl_b32 s61, s3, 15
    v_smfmac_f32_16x16x64_bf16 v[96:99], v[112:115], a[40:47], v125
    global_load_dword a204, v143, s[38:39] offset:0
    global_load_dword a205, v143, s[38:39] offset:1024
    s_add_u32 s60, s60, s61
    v_add_u32 v119, s60, v33
    v_lshrrev_b32 v34, 5, v34
    v_xor_b32 v119, v34, v119
    s_lshl_b32 s60, s3, 10
    v_lshl_add_u32 v33, v25, 12, s60
    v_lshl_add_u32 v120, v24, 6, v33
    v_smfmac_f32_16x16x64_bf16 v[96:99], v[112:115], a[48:55], v125
    global_load_dword a198, v142, s[38:39] offset:2048
    global_load_dword a199, v142, s[38:39] offset:3072
    v_lshl_add_u32 v33, v25, 2, v26
    v_lshl_add_u32 v120, v33, 2, v120
    v_mov_b32 v11, 0xdddd8888
    s_mov_b32 s61, 0xdddd8888
    s_cmp_eq_u32 s54, 1
    s_cselect_b32 s60, 0x8888dddd, s61
    v_mov_b32 v13, s60
    v_bfe_u32 v33, v1, 1, 1
    v_smfmac_f32_16x16x64_bf16 v[100:103], v[112:115], a[56:63], v125 abid:1
    global_load_dword a206, v143, s[38:39] offset:2048
    global_load_dword a207, v143, s[38:39] offset:3072
    v_bfe_u32 v34, v1, 2, 1
    v_bfe_u32 v35, v1, 3, 1
    v_lshl_add_u32 v36, v35, 1, v33
    v_xor_b32 v36, v36, v25
    s_lshl_b32 s60, s3, 11
    s_add_u32 s60, s60, 67584
    v_lshl_add_u32 v36, v36, 3, s60
    v_smfmac_f32_16x16x64_bf16 v[96:99], v[112:115], a[64:71], v125
    s_add_u32 s38, s70, 196608
    s_addc_u32 s39, s71, 0
    global_load_dword a208, v142, s[38:39] offset:-4096
    v_and_b32 v37, 1, v1
    v_lshl_add_u32 v37, v35, 1, v37
    v_lshl_add_u32 v37, v33, 3, v37
    v_mad_u32_u24 v37, v34, 18, v37
    v_lshl_add_u32 v14, v37, 5, v36
    v_mad_u32_u24 v37, v34, 6, v27
    v_mad_u32_u24 v37, v35, 10, v37
    v_smfmac_f32_16x16x64_bf16 v[96:99], v[112:115], a[72:79], v125
    global_load_dword a209, v142, s[38:39] offset:-3072
    v_lshl_add_u32 v37, v37, 5, v36
    v_add_u32 v16, 1088, v37
    v_lshl_add_u32 v36, v28, 1, v29
    v_xor_b32 v36, v36, v27
    v_lshl_add_u32 v36, v36, 3, s60
    v_and_b32 v37, 1, v26
    v_lshl_add_u32 v37, v37, 2, v32
    v_smfmac_f32_16x16x64_bf16 v[100:103], v[112:115], a[80:87], v125 abid:1
    global_load_dword a216, v143, s[38:39] offset:-4096
    v_lshl_add_u32 v37, v29, 3, v37
    v_lshl_add_u32 v15, v37, 5, v36
    v_lshl_add_u32 v36, v29, 1, v30
    v_xor_b32 v36, v36, v27
    v_lshl_add_u32 v36, v36, 3, s60
    v_mad_u32_u24 v37, v29, 10, v26
    v_lshl_add_u32 v37, v37, 5, v36
    v_smfmac_f32_16x16x64_bf16 v[96:99], v[112:115], a[88:95], v125
    s_branch PO_3
.p2align 12
PG_3:
    s_branch HOP_A
PO_3:
    global_load_dword a217, v143, s[38:39] offset:-3072
    v_add_u32 v17, 1088, v37
    s_lshl_b32 s60, s3, 10
    s_add_u32 s61, s60, 75776
    v_lshl_add_u32 v19, v1, 4, s61
    v_xor_b32 v18, 0x400, v19
    s_add_u32 s61, s60, 86016
    v_lshl_add_u32 v134, v1, 3, s61
    v_smfmac_f32_16x16x64_bf16 v[96:99], v[112:115], a[96:103], v125
    global_load_dword a210, v142, s[38:39] offset:-2048
    v_xor_b32 v131, 0x400, v134
    v_xor_b32 v132, 0x800, v134
    v_xor_b32 v133, 0xc00, v134
    s_mov_b32 s61, 65536
    v_lshl_add_u32 v20, v25, 5, s61
    s_mov_b32 s61, 66048
    v_lshl_add_u32 v21, v24, 2, s61
    v_smfmac_f32_16x16x64_bf16 v[100:103], v[112:115], a[104:111], v125 abid:1
    global_load_dword a211, v142, s[38:39] offset:-1024
    v_lshl_add_u32 v124, v1, 2, s61
    s_lshl_b32 s60, s3, 6
    v_add_u32 v33, s60, v21
    s_mov_b32 s61, 66560
    v_lshl_add_u32 v34, v1, 3, s61
    v_cmp_eq_u32 vcc, v26, v25
    s_nop 1
    v_cndmask_b32 v123, v34, v33, vcc
    v_smfmac_f32_16x16x64_bf16 v[96:99], v[112:115], a[112:119], v125
    global_load_dword a218, v143, s[38:39] offset:-2048
    s_lshl_b32 s60, s3, 7
    s_add_u32 s60, s60, 65536
    v_lshl_add_u32 v33, v24, 3, s60
    v_cndmask_b32 v122, v34, v33, vcc
    s_mul_i32 s60, s51, 180224
    s_mul_i32 s61, s3, 11264
    s_add_u32 s61, s61, s60
    v_smfmac_f32_16x16x64_bf16 v[96:99], v[112:115], a[120:127], v125
    global_load_dword a219, v143, s[38:39] offset:-1024
    s_lshl_b32 s62, s54, 5
    v_lshl_add_u32 v33, v1, 4, s61
    v_xor_b32 v130, s62, v33
    s_lshl_b32 s62, s52, 10
    s_cmp_eq_u32 s52, 7
    s_cselect_b32 s62, 1073741824, s62
    v_add_u32 v22, s62, v33
    s_lshl_b32 s61, s52, 1
    s_waitcnt vmcnt(63)
    v_smfmac_f32_16x16x64_bf16 v[100:103], v[112:115], a[128:135], v125 abid:1
    global_load_dword a212, v142, s[38:39] offset:0
    s_add_u32 s61, s61, s53
    s_and_b32 s62, s61, 3
    s_mul_i32 s62, s62, 11264
    s_add_u32 s60, s60, s62
    s_lshr_b32 s61, s61, 2
    s_lshl_b32 s61, s61, 10
    s_add_u32 s60, s60, s61
    v_smfmac_f32_16x16x64_bf16 v[96:99], v[112:115], a[136:143], v125
    global_load_dword a213, v142, s[38:39] offset:1024
    s_lshl_b32 s61, s54, 9
    s_add_u32 s60, s60, s61
    s_add_u32 s60, s60, 7168
    v_lshl_add_u32 v33, v29, 8, s60
    v_lshl_add_u32 v33, v24, 4, v33
    v_lshl_add_u32 v23, v28, 30, v33
    s_cmp_eq_u32 s3, 3
    s_cselect_b32 s78, 1073741824, 0
    v_smfmac_f32_16x16x64_bf16 v[96:99], v[112:115], a[144:151], v125
    global_load_dword a220, v143, s[38:39] offset:0
    s_lshl_b32 s60, s52, 13
    s_lshl_b32 s61, s53, 12
    s_add_u32 s60, s60, s61
    s_lshl_b32 s61, s54, 2
    s_add_u32 s60, s60, s61
    v_and_b32 v33, 1, v1
    v_lshl_add_u32 v33, v35, 1, v33
    s_waitcnt vmcnt(62)
    v_smfmac_f32_16x16x64_bf16 v[100:103], v[112:115], a[152:159], v125 abid:1
    global_load_dword a221, v143, s[38:39] offset:1024
    v_lshl_add_u32 v33, v33, 5, s60
    v_lshl_add_u32 v33, v25, 3, v33
    v_lshl_add_u32 v137, v24, 8, v33
    s_lshl_b32 s60, s51, 16
    s_lshl_b32 s61, s54, 11
    s_add_u32 s60, s60, s61
    s_lshl_b32 s61, s52, 7
    s_waitcnt vmcnt(55)
    v_smfmac_f32_16x16x64_bf16 v[96:99], v[112:115], a[160:167], v125
    global_load_dword a214, v142, s[38:39] offset:2048
    s_add_u32 s60, s60, s61
    s_lshl_b32 s61, s53, 6
    s_add_u32 s60, s60, s61
    v_lshl_add_u32 v33, v25, 12, s60
    v_lshl_add_u32 v136, v24, 2, v33
    v_and_b32 v33, 31, v1
    v_lshlrev_b32 v33, 2, v33
    s_waitcnt vmcnt(47)
    v_smfmac_f32_16x16x64_bf16 v[96:99], v[112:115], a[168:175], v125
    global_load_dword a215, v142, s[38:39] offset:3072
    v_lshl_add_u32 v141, v1, 7, v33
    s_lshl_b32 s60, s3, 8
    s_add_u32 s60, s60, 110592
    v_lshl_add_u32 v0, v1, 2, s60
    s_mov_b32 s61, 110592
    v_lshl_add_u32 v33, v27, 8, s61
    v_lshl_add_u32 v38, v1, 2, v33
    s_waitcnt vmcnt(40)
    v_smfmac_f32_16x16x64_bf16 v[100:103], v[112:115], a[176:183], v125 abid:1
    global_load_dword a222, v143, s[38:39] offset:2048
    s_lshl_b32 s60, s3, 11
    s_add_u32 s60, s60, 110592
    v_lshl_add_u32 v39, v1, 4, s60
    s_waitcnt vmcnt(33)
    v_smfmac_f32_16x16x64_bf16 v[96:99], v[112:115], a[184:191], v125
    global_load_dword a223, v143, s[38:39] offset:3072
    v_mov_b32 v40, 0
    v_mov_b32 v41, 0
    v_mov_b32 v42, 0
    v_mov_b32 v43, 0
    v_mov_b32 v44, 0
    v_mov_b32 v45, 0
    v_mov_b32 v46, 0
    v_mov_b32 v47, 0
    v_mov_b32 v48, 0
    v_mov_b32 v49, 0
    v_mov_b32 v50, 0
    v_mov_b32 v51, 0
    v_mov_b32 v52, 0
    v_mov_b32 v53, 0
    v_mov_b32 v54, 0
    v_mov_b32 v55, 0
    v_mov_b32 v64, 0
    v_mov_b32 v65, 0
    v_mov_b32 v66, 0
    v_mov_b32 v67, 0
    v_mov_b32 v68, 0
    v_mov_b32 v69, 0
    v_mov_b32 v70, 0
    v_mov_b32 v71, 0
    ds_write_b128 v39, v[40:43]
    ds_write_b128 v39, v[40:43] offset:1024
    v_cmp_gt_u32 vcc, 16, v1
    v_mov_b32 v1, v38
    v_cvt_pk_bf16_f32 v104, 0, v96
    v_sub_f32 v105, v96, v104
    v_cvt_pk_bf16_f32 v104, v104, v105
    v_cndmask_b32 v56, 0, v104, vcc
    v_mov_b32 v57, 0
    v_cvt_pk_bf16_f32 v104, 0, v97
    v_sub_f32 v105, v97, v104
    v_cvt_pk_bf16_f32 v104, v104, v105
    v_cndmask_b32 v58, 0, v104, vcc
    v_mov_b32 v59, 0
    v_cvt_pk_bf16_f32 v104, 0, v100
    v_sub_f32 v105, v100, v104
    v_cvt_pk_bf16_f32 v104, v104, v105
    v_cndmask_b32 v60, 0, v104, vcc
    v_mov_b32 v61, 0
    v_cvt_pk_bf16_f32 v104, 0, v101
    v_sub_f32 v105, v101, v104
    v_cvt_pk_bf16_f32 v104, v104, v105
    v_cndmask_b32 v62, 0, v104, vcc
    v_mov_b32 v63, 0
    v_mov_b32 v24, 0
    v_mov_b32 v25, 0
    v_mov_b32 v26, 0
    v_mov_b32 v27, 0
    v_mov_b32 v28, 0
    v_mov_b32 v29, 0
    v_mov_b32 v30, 0
    v_mov_b32 v31, 0
    v_mov_b32 v32, 0
    v_mov_b32 v33, 0
    v_mov_b32 v34, 0
    v_mov_b32 v35, 0
    v_mov_b32 v36, 0
    v_mov_b32 v37, 0
    v_mov_b32 v38, 0
    v_mov_b32 v39, 0
    s_mov_b32 s62, 0xaaaaaaaa
    s_mov_b32 s63, s62
    s_mov_b32 s64, 0xcccccccc
    s_mov_b32 s65, s64
    s_mov_b32 s69, 0
    s_mov_b32 s79, 0
    s_waitcnt vmcnt(32)
    s_waitcnt lgkmcnt(0)
S2_TRY:
    s_barrier
    s_lshl_b32 s61, s3, 10
    s_add_u32 m0, s61, 0
    s_mov_b32 s60, 0
    buffer_load_dwordx4 v119, s[40:43], s60 offen sc1 lds
    s_add_u32 m0, s61, 4096
    s_mov_b32 s60, 131072
    buffer_load_dwordx4 v119, s[40:43], s60 offen sc1 lds
    s_add_u32 m0, s61, 8192
    s_mov_b32 s60, 262144
    buffer_load_dwordx4 v119, s[40:43], s60 offen sc1 lds
    s_add_u32 m0, s61, 12288
    s_mov_b32 s60, 393216
    buffer_load_dwordx4 v119, s[40:43], s60 offen sc1 lds
    s_add_u32 m0, s61, 16384
    s_mov_b32 s60, 524288
    buffer_load_dwordx4 v119, s[40:43], s60 offen sc1 lds
    s_add_u32 m0, s61, 20480
    s_mov_b32 s60, 655360
    buffer_load_dwordx4 v119, s[40:43], s60 offen sc1 lds
    s_add_u32 m0, s61, 24576
    s_mov_b32 s60, 786432
    buffer_load_dwordx4 v119, s[40:43], s60 offen sc1 lds
    s_add_u32 m0, s61, 28672
    s_mov_b32 s60, 917504
    buffer_load_dwordx4 v119, s[40:43], s60 offen sc1 lds
    s_add_u32 m0, s61, 32768
    s_mov_b32 s60, 1048576
    buffer_load_dwordx4 v119, s[40:43], s60 offen sc1 lds
    s_add_u32 m0, s61, 36864
    s_mov_b32 s60, 1179648
    buffer_load_dwordx4 v119, s[40:43], s60 offen sc1 lds
    s_add_u32 m0, s61, 40960
    s_mov_b32 s60, 1310720
    buffer_load_dwordx4 v119, s[40:43], s60 offen sc1 lds
    s_add_u32 m0, s61, 45056
    s_mov_b32 s60, 1441792
    buffer_load_dwordx4 v119, s[40:43], s60 offen sc1 lds
    s_cmp_eq_u32 s3, 0
    s_cbranch_scc1 PG_4
    s_cmp_eq_u32 s3, 1
    s_cbranch_scc1 PG_5
HOP_B:
    s_waitcnt vmcnt(8)
CK_C0:
    s_barrier
    ds_read2st64_b32 v[126:127], v141 offset1:32
    ds_read_b64_tr_b16 v[96:97], v117 offset:0
    ds_read_b64_tr_b16 v[98:99], v117 offset:1024
    ds_read_b64_tr_b16 v[100:101], v118 offset:0
    ds_read_b64_tr_b16 v[102:103], v118 offset:1024
    ds_read_b64_tr_b16 v[72:73], v2 offset:0
    ds_read_b64_tr_b16 v[74:75], v2 offset:1024
    ds_read_b64_tr_b16 v[76:77], v3 offset:0
    ds_read_b64_tr_b16 v[78:79], v3 offset:1024
    s_waitcnt lgkmcnt(8)
    v_max_u32 v126, v126, v127
    v_cmp_eq_u32 vcc, -1, v126
    s_cbranch_vccnz CK_R0
CK_D0:
    s_waitcnt lgkmcnt(6)
    v_mfma_f32_16x16x32_bf16 v[68:71], v[96:99], v[96:99], v[68:71]
    ds_read_b64_tr_b16 v[104:105], v117 offset:8192
    s_add_u32 m0, s61, 49152
    s_mov_b32 s60, 1572864
    buffer_load_dwordx4 v119, s[40:43], s60 offen sc1 lds
    s_waitcnt lgkmcnt(5)
    v_mfma_f32_16x16x32_bf16 v[68:71], v[100:103], v[100:103], v[68:71]
    ds_read_b64_tr_b16 v[106:107], v117 offset:9216
    s_add_u32 s38, s70, 393216
    s_addc_u32 s39, s71, 0
    global_load_dword a224, v142, s[38:39] offset:-4096
    v_smfmac_f32_16x16x64_bf16 v[64:67], v[112:115], v[96:103], v116
    ds_read_b64_tr_b16 v[108:109], v118 offset:8192
    s_add_u32 m0, s61, 53248
    s_mov_b32 s60, 1703936
    buffer_load_dwordx4 v119, s[40:43], s60 offen sc1 lds
    global_load_dword a225, v142, s[38:39] offset:-3072
    s_waitcnt lgkmcnt(5)
    v_smfmac_f32_16x16x64_bf16 v[24:27], v[72:75], a[0:7], v11
    s_waitcnt vmcnt(8)
    ds_read_b32 v121, v120 offset:16384
    ds_read_b64_tr_b16 v[110:111], v118 offset:9216
    global_load_dword a232, v143, s[38:39] offset:-4096
    v_smfmac_f32_16x16x64_bf16 v[28:31], v[72:75], a[0:7], v11 abid:1
    ds_read_b64_tr_b16 v[80:81], v2 offset:8192
    s_add_u32 m0, s61, 57344
    s_mov_b32 s60, 1835008
    buffer_load_dwordx4 v119, s[40:43], s60 offen sc1 lds
    global_load_dword a233, v143, s[38:39] offset:-3072
    v_smfmac_f32_16x16x64_bf16 v[32:35], v[72:75], a[8:15], v13
    ds_read_b64_tr_b16 v[82:83], v2 offset:9216
    v_smfmac_f32_16x16x64_bf16 v[36:39], v[72:75], a[8:15], v13 abid:1
    ds_read_b64_tr_b16 v[84:85], v3 offset:8192
    s_add_u32 m0, s61, 61440
    s_mov_b32 s60, 1966080
    buffer_load_dwordx4 v119, s[40:43], s60 offen sc1 lds
    global_load_dword a226, v142, s[38:39] offset:-2048
    s_waitcnt lgkmcnt(8)
    v_smfmac_f32_16x16x64_bf16 v[24:27], v[76:79], a[16:23], v11
    ds_read_b64_tr_b16 v[86:87], v3 offset:9216
    global_load_dword a227, v142, s[38:39] offset:-1024
    v_smfmac_f32_16x16x64_bf16 v[28:31], v[76:79], a[16:23], v11 abid:1
    s_waitcnt lgkmcnt(5)
    v_cmp_eq_u32 vcc, -1, v121
    s_cbranch_vccnz CK_R1
CK_C1:
    s_barrier
    s_waitcnt lgkmcnt(0)
    global_load_dword a234, v143, s[38:39] offset:-2048
    v_mfma_f32_16x16x32_bf16 v[68:71], v[104:107], v[104:107], v[68:71]
    ds_read_b64_tr_b16 v[96:97], v117 offset:16384
    global_load_dword a235, v143, s[38:39] offset:-1024
    v_mfma_f32_16x16x32_bf16 v[68:71], v[108:111], v[108:111], v[68:71]
    ds_read_b64_tr_b16 v[98:99], v117 offset:17408
    v_smfmac_f32_16x16x64_bf16 v[64:67], v[112:115], v[104:111], v116
    ds_read_b64_tr_b16 v[100:101], v118 offset:16384
    global_load_dword a228, v142, s[38:39] offset:0
    v_smfmac_f32_16x16x64_bf16 v[24:27], v[80:83], a[24:31], v11
    ds_read_b64_tr_b16 v[102:103], v118 offset:17408
    global_load_dword a229, v142, s[38:39] offset:1024
    v_smfmac_f32_16x16x64_bf16 v[28:31], v[80:83], a[24:31], v11 abid:1
    ds_read_b64_tr_b16 v[88:89], v2 offset:16384
    global_load_dword a236, v143, s[38:39] offset:0
    v_smfmac_f32_16x16x64_bf16 v[32:35], v[80:83], a[32:39], v13
    ds_read_b64_tr_b16 v[90:91], v2 offset:17408
    v_smfmac_f32_16x16x64_bf16 v[36:39], v[80:83], a[32:39], v13 abid:1
    ds_read_b64_tr_b16 v[92:93], v3 offset:16384
    global_load_dword a237, v143, s[38:39] offset:1024
    v_smfmac_f32_16x16x64_bf16 v[24:27], v[84:87], a[40:47], v11
    ds_read_b64_tr_b16 v[94:95], v3 offset:17408
    global_load_dword a230, v142, s[38:39] offset:2048
    v_smfmac_f32_16x16x64_bf16 v[28:31], v[84:87], a[40:47], v11 abid:1
    s_waitcnt lgkmcnt(0)
    global_load_dword a231, v142, s[38:39] offset:3072
    v_mfma_f32_16x16x32_bf16 v[68:71], v[96:99], v[96:99], v[68:71]
    ds_read_b64_tr_b16 v[104:105], v117 offset:24576
    global_load_dword a238, v143, s[38:39] offset:2048
    v_mfma_f32_16x16x32_bf16 v[68:71], v[100:103], v[100:103], v[68:71]
    ds_read_b64_tr_b16 v[106:107], v117 offset:25600
    v_smfmac_f32_16x16x64_bf16 v[64:67], v[112:115], v[96:103], v116
    ds_read_b64_tr_b16 v[108:109], v118 offset:24576
    global_load_dword a239, v143, s[38:39] offset:3072
    v_smfmac_f32_16x16x64_bf16 v[24:27], v[88:91], a[48:55], v11
    s_waitcnt vmcnt(20)
    ds_read_b32 v121, v120 offset:32768
    ds_read_b64_tr_b16 v[110:111], v118 offset:25600
    s_add_u32 s38, s70, 589824
    s_addc_u32 s39, s71, 0
    global_load_dword a240, v142, s[38:39] offset:-4096
    v_smfmac_f32_16x16x64_bf16 v[28:31], v[88:91], a[48:55], v11 abid:1
    ds_read_b64_tr_b16 v[72:73], v2 offset:24576
    global_load_dword a241, v142, s[38:39] offset:-3072
    v_smfmac_f32_16x16x64_bf16 v[32:35], v[88:91], a[56:63], v13
    ds_read_b64_tr_b16 v[74:75], v2 offset:25600
    v_smfmac_f32_16x16x64_bf16 v[36:39], v[88:91], a[56:63], v13 abid:1
    ds_read_b64_tr_b16 v[76:77], v3 offset:24576
    global_load_dword a248, v143, s[38:39] offset:-4096
    v_smfmac_f32_16x16x64_bf16 v[24:27], v[92:95], a[64:71], v11
    ds_read_b64_tr_b16 v[78:79], v3 offset:25600
    global_load_dword a249, v143, s[38:39] offset:-3072
    v_smfmac_f32_16x16x64_bf16 v[28:31], v[92:95], a[64:71], v11 abid:1
    s_waitcnt lgkmcnt(5)
    v_cmp_eq_u32 vcc, -1, v121
    s_cbranch_vccnz CK_R2
CK_C2:
    s_barrier
    s_waitcnt lgkmcnt(0)
    global_load_dword a242, v142, s[38:39] offset:-2048
    v_mfma_f32_16x16x32_bf16 v[68:71], v[104:107], v[104:107], v[68:71]
    ds_read_b64_tr_b16 v[96:97], v117 offset:32768
    global_load_dword a243, v142, s[38:39] offset:-1024
    v_mfma_f32_16x16x32_bf16 v[68:71], v[108:111], v[108:111], v[68:71]
    ds_read_b64_tr_b16 v[98:99], v117 offset:33792
    v_smfmac_f32_16x16x64_bf16 v[64:67], v[112:115], v[104:111], v116
    ds_read_b64_tr_b16 v[100:101], v118 offset:32768
    global_load_dword a250, v143, s[38:39] offset:-2048
    v_smfmac_f32_16x16x64_bf16 v[24:27], v[72:75], a[72:79], v11
    ds_read_b64_tr_b16 v[102:103], v118 offset:33792
    global_load_dword a251, v143, s[38:39] offset:-1024
    v_smfmac_f32_16x16x64_bf16 v[28:31], v[72:75], a[72:79], v11 abid:1
    ds_read_b64_tr_b16 v[80:81], v2 offset:32768
    global_load_dword a244, v142, s[38:39] offset:0
    v_smfmac_f32_16x16x64_bf16 v[32:35], v[72:75], a[80:87], v13
    ds_read_b64_tr_b16 v[82:83], v2 offset:33792
    global_load_dword a245, v142, s[38:39] offset:1024
    v_smfmac_f32_16x16x64_bf16 v[36:39], v[72:75], a[80:87], v13 abid:1
    ds_read_b64_tr_b16 v[84:85], v3 offset:32768
    v_smfmac_f32_16x16x64_bf16 v[24:27], v[76:79], a[88:95], v11
    ds_read_b64_tr_b16 v[86:87], v3 offset:33792
    global_load_dword a252, v143, s[38:39] offset:0
    v_smfmac_f32_16x16x64_bf16 v[28:31], v[76:79], a[88:95], v11 abid:1
    s_waitcnt lgkmcnt(0)
    global_load_dword a253, v143, s[38:39] offset:1024
    v_mfma_f32_16x16x32_bf16 v[68:71], v[96:99], v[96:99], v[68:71]
    ds_read_b64_tr_b16 v[104:105], v117 offset:40960
    global_load_dword a246, v142, s[38:39] offset:2048
    v_mfma_f32_16x16x32_bf16 v[68:71], v[100:103], v[100:103], v[68:71]
    ds_read_b64_tr_b16 v[106:107], v117 offset:41984
    v_smfmac_f32_16x16x64_bf16 v[64:67], v[112:115], v[96:103], v116
    ds_read_b64_tr_b16 v[108:109], v118 offset:40960
    global_load_dword a247, v142, s[38:39] offset:3072
    v_smfmac_f32_16x16x64_bf16 v[24:27], v[80:83], a[96:103], v11
    s_waitcnt vmcnt(26)
    ds_read_b32 v121, v120 offset:49152
    ds_read_b64_tr_b16 v[110:111], v118 offset:41984
    global_load_dword a254, v143, s[38:39] offset:2048
    v_smfmac_f32_16x16x64_bf16 v[28:31], v[80:83], a[96:103], v11 abid:1
    ds_read_b64_tr_b16 v[88:89], v2 offset:40960
    global_load_dword a255, v143, s[38:39] offset:3072
    v_smfmac_f32_16x16x64_bf16 v[32:35], v[80:83], a[104:111], v13
    ds_read_b64_tr_b16 v[90:91], v2 offset:41984
    s_add_u32 s38, s70, 786432
    s_addc_u32 s39, s71, 0
    global_load_dword v144, v142, s[38:39] offset:-4096
    v_smfmac_f32_16x16x64_bf16 v[36:39], v[80:83], a[104:111], v13 abid:1
    ds_read_b64_tr_b16 v[92:93], v3 offset:40960
    v_smfmac_f32_16x16x64_bf16 v[24:27], v[84:87], a[112:119], v11
    ds_read_b64_tr_b16 v[94:95], v3 offset:41984
    global_load_dword v145, v142, s[38:39] offset:-3072
    v_smfmac_f32_16x16x64_bf16 v[28:31], v[84:87], a[112:119], v11 abid:1
    s_waitcnt lgkmcnt(5)
    v_cmp_eq_u32 vcc, -1, v121
    s_cbranch_vccnz CK_R3
CK_C3:
    s_barrier
    s_waitcnt lgkmcnt(0)
    global_load_dword v152, v143, s[38:39] offset:-4096
    v_mfma_f32_16x16x32_bf16 v[68:71], v[104:107], v[104:107], v[68:71]
    ds_read_b64_tr_b16 v[96:97], v117 offset:49152
    global_load_dword v153, v143, s[38:39] offset:-3072
    v_mfma_f32_16x16x32_bf16 v[68:71], v[108:111], v[108:111], v[68:71]
    ds_read_b64_tr_b16 v[98:99], v117 offset:50176
    v_smfmac_f32_16x16x64_bf16 v[64:67], v[112:115], v[104:111], v116
    ds_read_b64_tr_b16 v[100:101], v118 offset:49152
    global_load_dword v146, v142, s[38:39] offset:-2048
    v_smfmac_f32_16x16x64_bf16 v[24:27], v[88:91], a[120:127], v11
    ds_read_b64_tr_b16 v[102:103], v118 offset:50176
    global_load_dword v147, v142, s[38:39] offset:-1024
    v_smfmac_f32_16x16x64_bf16 v[28:31], v[88:91], a[120:127], v11 abid:1
    ds_read_b64_tr_b16 v[72:73], v2 offset:49152
    global_load_dword v154, v143, s[38:39] offset:-2048
    v_smfmac_f32_16x16x64_bf16 v[32:35], v[88:91], a[128:135], v13
    ds_read_b64_tr_b16 v[74:75], v2 offset:50176
    global_load_dword v155, v143, s[38:39] offset:-1024
    v_smfmac_f32_16x16x64_bf16 v[36:39], v[88:91], a[128:135], v13 abid:1
    ds_read_b64_tr_b16 v[76:77], v3 offset:49152
    v_smfmac_f32_16x16x64_bf16 v[24:27], v[92:95], a[136:143], v11
    ds_read_b64_tr_b16 v[78:79], v3 offset:50176
    global_load_dword v148, v142, s[38:39] offset:0
    v_smfmac_f32_16x16x64_bf16 v[28:31], v[92:95], a[136:143], v11 abid:1
    s_waitcnt lgkmcnt(0)
    global_load_dword v149, v142, s[38:39] offset:1024
    v_mfma_f32_16x16x32_bf16 v[68:71], v[96:99], v[96:99], v[68:71]
    ds_read_b64_tr_b16 v[104:105], v117 offset:57344
    global_load_dword v156, v143, s[38:39] offset:0
    v_mfma_f32_16x16x32_bf16 v[68:71], v[100:103], v[100:103], v[68:71]
    ds_read_b64_tr_b16 v[106:107], v117 offset:58368
    global_load_dword v157, v143, s[38:39] offset:1024
    v_smfmac_f32_16x16x64_bf16 v[64:67], v[112:115], v[96:103], v116
    ds_read_b64_tr_b16 v[108:109], v118 offset:57344
    v_smfmac_f32_16x16x64_bf16 v[24:27], v[72:75], a[144:151], v11
    ds_read_b64_tr_b16 v[110:111], v118 offset:58368
    global_load_dword v150, v142, s[38:39] offset:2048
    v_smfmac_f32_16x16x64_bf16 v[28:31], v[72:75], a[144:151], v11 abid:1
    ds_read_b64_tr_b16 v[80:81], v2 offset:57344
    global_load_dword v151, v142, s[38:39] offset:3072
    v_smfmac_f32_16x16x64_bf16 v[32:35], v[72:75], a[152:159], v13
    ds_read_b64_tr_b16 v[82:83], v2 offset:58368
    global_load_dword v158, v143, s[38:39] offset:2048
    v_smfmac_f32_16x16x64_bf16 v[36:39], v[72:75], a[152:159], v13 abid:1
    ds_read_b64_tr_b16 v[84:85], v3 offset:57344
    v_smfmac_f32_16x16x64_bf16 v[24:27], v[76:79], a[160:167], v11
    ds_read_b64_tr_b16 v[86:87], v3 offset:58368
    global_load_dword v159, v143, s[38:39] offset:3072
    v_smfmac_f32_16x16x64_bf16 v[28:31], v[76:79], a[160:167], v11 abid:1
    s_waitcnt lgkmcnt(0)
    s_add_u32 s38, s70, 983040
    s_addc_u32 s39, s71, 0
    global_load_dword v160, v142, s[38:39] offset:-4096
    v_mfma_f32_16x16x32_bf16 v[68:71], v[104:107], v[104:107], v[68:71]
    ds_read_b64_tr_b16 v[88:89], v4 offset:0
    global_load_dword v161, v142, s[38:39] offset:-3072
    v_mfma_f32_16x16x32_bf16 v[68:71], v[108:111], v[108:111], v[68:71]
    ds_read_b64_tr_b16 v[90:91], v4 offset:1024
    global_load_dword v168, v143, s[38:39] offset:-4096
    v_smfmac_f32_16x16x64_bf16 v[64:67], v[112:115], v[104:111], v116
    ds_read_b64_tr_b16 v[92:93], v5 offset:0
    v_smfmac_f32_16x16x64_bf16 v[24:27], v[80:83], a[168:175], v11
    ds_read_b64_tr_b16 v[94:95], v5 offset:1024
    global_load_dword v169, v143, s[38:39] offset:-3072
    v_smfmac_f32_16x16x64_bf16 v[28:31], v[80:83], a[168:175], v11 abid:1
    ds_read_b64_tr_b16 v[72:73], v4 offset:8192
    global_load_dword v162, v142, s[38:39] offset:-2048
    v_smfmac_f32_16x16x64_bf16 v[32:35], v[80:83], a[176:183], v13
    ds_read_b64_tr_b16 v[74:75], v4 offset:9216
    global_load_dword v163, v142, s[38:39] offset:-1024
    v_smfmac_f32_16x16x64_bf16 v[36:39], v[80:83], a[176:183], v13 abid:1
    ds_read_b64_tr_b16 v[76:77], v5 offset:8192
    v_smfmac_f32_16x16x64_bf16 v[24:27], v[84:87], a[184:191], v11
    ds_read_b64_tr_b16 v[78:79], v5 offset:9216
    global_load_dword v170, v143, s[38:39] offset:-2048
    v_add_f32 v125, v64, v65
    v_cndmask_b32 v126, v68, v69, s[62:63]
    v_cndmask_b32 v127, v70, v71, s[62:63]
    v_smfmac_f32_16x16x64_bf16 v[28:31], v[84:87], a[184:191], v11 abid:1
    s_waitcnt lgkmcnt(4)
    global_load_dword v171, v143, s[38:39] offset:-1024
    v_mul_f32 v125, 0x3b000000, v125
    v_cndmask_b32 v126, v126, v127, s[64:65]
    v_mul_f32 v126, 0x3b000000, v126
    v_smfmac_f32_16x16x64_bf16 v[40:43], v[88:91], a[0:7], v11
    ds_read_b64_tr_b16 v[80:81], v4 offset:16384
    global_load_dword v164, v142, s[38:39] offset:0
    v_fma_f32 v126, -v125, v125, v126
    v_max_f32 v126, 0, v126
    v_smfmac_f32_16x16x64_bf16 v[44:47], v[88:91], a[0:7], v11 abid:1
    ds_read_b64_tr_b16 v[82:83], v4 offset:17408
    global_load_dword v165, v142, s[38:39] offset:1024
    v_cvt_pk_bf16_f32 v126, 0, v126
    v_add_f32 v126, 0x3727c5ac, v126
    v_cvt_pk_bf16_f32 v126, 0, v126
    v_smfmac_f32_16x16x64_bf16 v[48:51], v[88:91], a[8:15], v13
    ds_read_b64_tr_b16 v[84:85], v5 offset:16384
    v_sqrt_f32 v126, v126
    v_smfmac_f32_16x16x64_bf16 v[52:55], v[88:91], a[8:15], v13 abid:1
    ds_read_b64_tr_b16 v[86:87], v5 offset:17408
    global_load_dword v172, v143, s[38:39] offset:0
    v_cvt_pk_bf16_f32 v127, -v125, -v125
    v_cvt_pk_bf16_f32 v129, 0, v126
    v_smfmac_f32_16x16x64_bf16 v[40:43], v[92:95], a[16:23], v11
    global_load_dword v173, v143, s[38:39] offset:1024
    v_rcp_f32 v128, v129
    s_nop 0
    v_mul_f32 v128, 0xbfb8aa3b, v128
    v_smfmac_f32_16x16x64_bf16 v[44:47], v[92:95], a[16:23], v11 abid:1
    ds_write_b32 v123, v127
    global_load_dword v166, v142, s[38:39] offset:2048
    s_waitcnt lgkmcnt(5)
    v_smfmac_f32_16x16x64_bf16 v[40:43], v[72:75], a[24:31], v11
    ds_read_b64_tr_b16 v[88:89], v4 offset:24576
    ds_write_b64 v122, v[128:129]
    global_load_dword v167, v142, s[38:39] offset:3072
    v_smfmac_f32_16x16x64_bf16 v[44:47], v[72:75], a[24:31], v11 abid:1
    ds_read_b64_tr_b16 v[90:91], v4 offset:25600
    v_smfmac_f32_16x16x64_bf16 v[48:51], v[72:75], a[32:39], v13
    ds_read_b64_tr_b16 v[92:93], v5 offset:24576
    global_load_dword v174, v143, s[38:39] offset:2048
    v_smfmac_f32_16x16x64_bf16 v[52:55], v[72:75], a[32:39], v13 abid:1
    ds_read_b64_tr_b16 v[94:95], v5 offset:25600
    global_load_dword v175, v143, s[38:39] offset:3072
    v_smfmac_f32_16x16x64_bf16 v[40:43], v[76:79], a[40:47], v11
    s_add_u32 s38, s70, 1179648
    s_addc_u32 s39, s71, 0
    global_load_dword v176, v142, s[38:39] offset:-4096
    s_waitcnt lgkmcnt(3)
    s_barrier
    v_smfmac_f32_16x16x64_bf16 v[44:47], v[76:79], a[40:47], v11 abid:1
    ds_read_b32 v10, v21 offset:0
    v_smfmac_f32_16x16x64_bf16 v[40:43], v[80:83], a[48:55], v11
    ds_read_b64_tr_b16 v[72:73], v4 offset:32768
    ds_read_b32 v121, v124
    global_load_dword v177, v142, s[38:39] offset:-3072
    v_smfmac_f32_16x16x64_bf16 v[44:47], v[80:83], a[48:55], v11 abid:1
    ds_read_b64_tr_b16 v[74:75], v4 offset:33792
    ds_read_b128 v[64:67], v20 offset:0
    global_load_dword v184, v143, s[38:39] offset:-4096
    v_smfmac_f32_16x16x64_bf16 v[48:51], v[80:83], a[56:63], v13
    ds_read_b64_tr_b16 v[76:77], v5 offset:32768
    ds_read_b128 v[68:71], v20 offset:16
    global_load_dword v185, v143, s[38:39] offset:-3072
    v_smfmac_f32_16x16x64_bf16 v[52:55], v[80:83], a[56:63], v13 abid:1
    ds_read_b64_tr_b16 v[78:79], v5 offset:33792
    global_load_dword v178, v142, s[38:39] offset:-2048
    v_smfmac_f32_16x16x64_bf16 v[40:43], v[84:87], a[64:71], v11
    v_smfmac_f32_16x16x64_bf16 v[44:47], v[84:87], a[64:71], v11 abid:1
    global_load_dword v179, v142, s[38:39] offset:-1024
    s_waitcnt lgkmcnt(8)
    v_smfmac_f32_16x16x64_bf16 v[40:43], v[88:91], a[72:79], v11
    ds_read_b64_tr_b16 v[80:81], v4 offset:40960
    global_load_dword v186, v143, s[38:39] offset:-2048
    v_smfmac_f32_16x16x64_bf16 v[44:47], v[88:91], a[72:79], v11 abid:1
    ds_read_b64_tr_b16 v[82:83], v4 offset:41984
    global_load_dword v187, v143, s[38:39] offset:-1024
    s_waitcnt lgkmcnt(3)
    v_mfma_f32_16x16x16_bf16 v[36:39], v[10:11], v[62:63], v[36:39]
    v_cmp_u_f32 vcc, v121, v121
    v_mfma_f32_16x16x16_bf16 v[24:27], v[10:11], v[56:57], v[24:27]
    global_load_dword v180, v142, s[38:39] offset:0
    s_cbranch_vccnz S2_REDO
S2_GO:
    s_mov_b64 vcc, s[48:49]
    v_mfma_f32_16x16x16_bf16 v[28:31], v[10:11], v[58:59], v[28:31]
    global_load_dword v181, v142, s[38:39] offset:1024
    v_mfma_f32_16x16x16_bf16 v[32:35], v[10:11], v[60:61], v[32:35]
    global_load_dword v188, v143, s[38:39] offset:0
    v_smfmac_f32_16x16x64_bf16 v[48:51], v[88:91], a[80:87], v13
    ds_read_b64_tr_b16 v[84:85], v5 offset:40960
    global_load_dword v189, v143, s[38:39] offset:1024
    v_smfmac_f32_16x16x64_bf16 v[52:55], v[88:91], a[80:87], v13 abid:1
    ds_read_b64_tr_b16 v[86:87], v5 offset:41984
    ds_write_b128 v18, v[36:39] offset:0
    v_smfmac_f32_16x16x64_bf16 v[40:43], v[92:95], a[88:95], v11
    ds_write_b32 v0, v0 offset:0
    global_load_dword v182, v142, s[38:39] offset:2048
    v_mul_f32 v96, v24, v64
    v_mul_f32 v97, v25, v66
    v_mul_f32 v98, v26, v68
    v_mul_f32 v99, v27, v70
    v_smfmac_f32_16x16x64_bf16 v[44:47], v[92:95], a[88:95], v11 abid:1
    global_load_dword v183, v142, s[38:39] offset:3072
    s_waitcnt lgkmcnt(6)
    v_mul_f32 v100, v28, v64
    v_mul_f32 v101, v29, v66
    v_mul_f32 v102, v30, v68
    v_mul_f32 v103, v31, v70
    v_smfmac_f32_16x16x64_bf16 v[40:43], v[72:75], a[96:103], v11
    ds_read_b64_tr_b16 v[88:89], v4 offset:49152
    global_load_dword v190, v143, s[38:39] offset:2048
    v_exp_f32 v96, v96
    v_exp_f32 v97, v97
    s_branch PO_4
.p2align 12
PG_4:
    s_branch HOP_B
PO_4:
    v_smfmac_f32_16x16x64_bf16 v[44:47], v[72:75], a[96:103], v11 abid:1
    ds_read_b64_tr_b16 v[90:91], v4 offset:50176
    global_load_dword v191, v143, s[38:39] offset:3072
    v_exp_f32 v98, v98
    v_smfmac_f32_16x16x64_bf16 v[48:51], v[72:75], a[104:111], v13
    ds_read_b64_tr_b16 v[92:93], v5 offset:49152
    v_exp_f32 v99, v99
    v_exp_f32 v100, v100
    v_smfmac_f32_16x16x64_bf16 v[52:55], v[72:75], a[104:111], v13 abid:1
    ds_read_b64_tr_b16 v[94:95], v5 offset:50176
    s_add_u32 s38, s72, 0
    s_addc_u32 s39, s73, 0
    global_load_dword v192, v142, s[38:39] offset:-4096
    v_exp_f32 v101, v101
    v_exp_f32 v102, v102
    v_smfmac_f32_16x16x64_bf16 v[40:43], v[76:79], a[112:119], v11
    ds_read_b32 v12, v21 offset:64
    global_load_dword v193, v142, s[38:39] offset:-2048
    v_exp_f32 v103, v103
    v_fma_f32 v96, v96, v65, v65
    v_fma_f32 v97, v97, v67, v67
    v_smfmac_f32_16x16x64_bf16 v[44:47], v[76:79], a[112:119], v11 abid:1
    global_load_dword v200, v143, s[38:39] offset:-4096
    s_waitcnt lgkmcnt(7)
    v_fma_f32 v98, v98, v69, v69
    v_fma_f32 v99, v99, v71, v71
    v_fma_f32 v100, v100, v65, v65
    v_smfmac_f32_16x16x64_bf16 v[40:43], v[80:83], a[120:127], v11
    ds_read_b64_tr_b16 v[72:73], v4 offset:57344
    v_fma_f32 v101, v101, v67, v67
    v_fma_f32 v102, v102, v69, v69
    v_fma_f32 v103, v103, v71, v71
    v_rcp_f32 v96, v96
    v_smfmac_f32_16x16x64_bf16 v[44:47], v[80:83], a[120:127], v11 abid:1
    ds_read_b64_tr_b16 v[74:75], v4 offset:58368
    global_load_dword v201, v143, s[38:39] offset:-2048
    v_rcp_f32 v97, v97
    v_smfmac_f32_16x16x64_bf16 v[48:51], v[80:83], a[128:135], v13
    ds_read_b64_tr_b16 v[76:77], v5 offset:57344
    ds_read_b32 v121, v1 offset:0
    ds_read_b128 v[108:111], v19 offset:0
    global_load_dword v194, v142, s[38:39] offset:0
    v_rcp_f32 v98, v98
    v_rcp_f32 v99, v99
    v_smfmac_f32_16x16x64_bf16 v[52:55], v[80:83], a[128:135], v13 abid:1
    ds_read_b64_tr_b16 v[78:79], v5 offset:58368
    global_load_dword v195, v142, s[38:39] offset:2048
    v_rcp_f32 v100, v100
    v_rcp_f32 v101, v101
    v_smfmac_f32_16x16x64_bf16 v[40:43], v[84:87], a[136:143], v11
    ds_read_b128 v[112:115], v20 offset:128
    global_load_dword v202, v143, s[38:39] offset:0
    v_rcp_f32 v102, v102
    v_rcp_f32 v103, v103
    v_smfmac_f32_16x16x64_bf16 v[44:47], v[84:87], a[136:143], v11 abid:1
    ds_read_b128 v[116:119], v20 offset:144
    s_waitcnt lgkmcnt(9)
    v_mul_f32 v96, v96, v24
    v_mul_f32 v97, v97, v25
    v_mul_f32 v98, v98, v26
    v_smfmac_f32_16x16x64_bf16 v[40:43], v[88:91], a[144:151], v11
    ds_read_b64_tr_b16 v[80:81], v6 offset:0
    global_load_dword v203, v143, s[38:39] offset:2048
    v_mul_f32 v99, v99, v27
    v_mul_f32 v100, v100, v28
    v_mul_f32 v101, v101, v29
    v_mul_f32 v102, v102, v30
    v_smfmac_f32_16x16x64_bf16 v[44:47], v[88:91], a[144:151], v11 abid:1
    ds_read_b64_tr_b16 v[82:83], v6 offset:1024
    global_load_dword v196, v142, s[38:39] offset:-3072
    s_waitcnt lgkmcnt(5)
    v_cmp_eq_u32 vcc, 0, v121
    s_cbranch_vccnz FL_R0
FL_C0:
    v_mul_f32 v103, v103, v31
    v_cvt_pk_bf16_f32 v96, v96, v97
    v_cvt_pk_bf16_f32 v97, v98, v99
    v_smfmac_f32_16x16x64_bf16 v[48:51], v[88:91], a[152:159], v13
    ds_read_b64_tr_b16 v[84:85], v7 offset:0
    ds_write_b64 v14, v[96:97]
    global_load_dword v197, v142, s[38:39] offset:-1024
    v_cvt_pk_bf16_f32 v100, v100, v101
    v_cvt_pk_bf16_f32 v101, v102, v103
    v_add_f32 v32, v32, v108
    v_add_f32 v33, v33, v109
    v_smfmac_f32_16x16x64_bf16 v[52:55], v[88:91], a[152:159], v13 abid:1
    ds_read_b64_tr_b16 v[86:87], v7 offset:1024
    ds_write_b64 v14, v[100:101] offset:128
    v_add_f32 v34, v34, v110
    v_add_f32 v35, v35, v111
    v_mul_f32 v104, v32, v64
    v_mul_f32 v105, v33, v66
    v_smfmac_f32_16x16x64_bf16 v[40:43], v[92:95], a[160:167], v11
    ds_read_b64_tr_b16 v[100:101], v15
    ds_read_b32 v10, v21 offset:128
    global_load_dword v204, v143, s[38:39] offset:-3072
    v_mul_f32 v106, v34, v68
    v_mul_f32 v107, v35, v70
    v_exp_f32 v104, v104
    v_smfmac_f32_16x16x64_bf16 v[44:47], v[92:95], a[160:167], v11 abid:1
    ds_read_b64_tr_b16 v[102:103], v15 offset:576
    global_load_dword v205, v143, s[38:39] offset:-1024
    s_waitcnt lgkmcnt(11)
    v_exp_f32 v105, v105
    v_smfmac_f32_16x16x64_bf16 v[40:43], v[72:75], a[168:175], v11
    ds_read_b64_tr_b16 v[88:89], v6 offset:8192
    global_load_dword v198, v142, s[38:39] offset:1024
    v_exp_f32 v106, v106
    v_exp_f32 v107, v107
    v_smfmac_f32_16x16x64_bf16 v[44:47], v[72:75], a[168:175], v11 abid:1
    ds_read_b64_tr_b16 v[90:91], v6 offset:9216
    global_load_dword v199, v142, s[38:39] offset:3072
    v_fma_f32 v104, v104, v65, v65
    v_fma_f32 v105, v105, v67, v67
    v_fma_f32 v106, v106, v69, v69
    v_fma_f32 v107, v107, v71, v71
    v_smfmac_f32_16x16x64_bf16 v[48:51], v[72:75], a[176:183], v13
    ds_read_b64_tr_b16 v[92:93], v7 offset:8192
    v_rcp_f32 v104, v104
    v_rcp_f32 v105, v105
    v_smfmac_f32_16x16x64_bf16 v[52:55], v[72:75], a[176:183], v13 abid:1
    ds_read_b64_tr_b16 v[94:95], v7 offset:9216
    global_load_dword v206, v143, s[38:39] offset:1024
    v_rcp_f32 v106, v106
    v_rcp_f32 v107, v107
    v_smfmac_f32_16x16x64_bf16 v[40:43], v[76:79], a[184:191], v11
    global_load_dword v207, v143, s[38:39] offset:3072
    v_mul_f32 v104, v104, v32
    v_mul_f32 v105, v105, v33
    v_mul_f32 v106, v106, v34
    v_smfmac_f32_16x16x64_bf16 v[44:47], v[76:79], a[184:191], v11 abid:1
    s_add_u32 s38, s72, 393216
    s_addc_u32 s39, s73, 0
    global_load_dword v208, v142, s[38:39] offset:-4096
    s_waitcnt lgkmcnt(8)
    s_waitcnt lgkmcnt(4)
    s_mov_b32 s68, 0
    v_mul_f32 v107, v107, v35
    v_cvt_pk_bf16_f32 v104, v104, v105
    v_cvt_pk_bf16_f32 v105, v106, v107
    v_mfma_f32_16x16x16_bf16 v[36:39], v[10:11], v[62:63], 0
    buffer_store_dwordx4 v[100:103], v22, s[44:47], s68 offen sc1
    ds_write_b64 v16, v[104:105]
    global_load_dword v209, v142, s[38:39] offset:-2048
    v_mfma_f32_16x16x16_bf16 v[24:27], v[10:11], v[56:57], 0
    ds_read_b64_tr_b16 v[104:105], v17
    v_mfma_f32_16x16x16_bf16 v[28:31], v[10:11], v[58:59], 0
    ds_read_b64_tr_b16 v[106:107], v17 offset:192
    global_load_dword v216, v143, s[38:39] offset:-4096
    v_mfma_f32_16x16x16_bf16 v[32:35], v[10:11], v[60:61], 0
    global_load_dword v217, v143, s[38:39] offset:-2048
    v_smfmac_f32_16x16x64_bf16 v[24:27], v[80:83], a[0:7], v11
    ds_read_b64_tr_b16 v[72:73], v6 offset:16384
    global_load_dword v210, v142, s[38:39] offset:0
    v_mfma_f32_16x16x16_bf16 v[52:55], v[12:13], v[62:63], v[52:55]
    v_mfma_f32_16x16x16_bf16 v[40:43], v[12:13], v[56:57], v[40:43]
    global_load_dword v211, v142, s[38:39] offset:2048
    v_mfma_f32_16x16x16_bf16 v[44:47], v[12:13], v[58:59], v[44:47]
    global_load_dword v218, v143, s[38:39] offset:0
    v_mfma_f32_16x16x16_bf16 v[48:51], v[12:13], v[60:61], v[48:51]
    global_load_dword v219, v143, s[38:39] offset:2048
    s_waitcnt lgkmcnt(1)
    v_smfmac_f32_16x16x64_bf16 v[28:31], v[80:83], a[0:7], v11 abid:1
    ds_read_b64_tr_b16 v[74:75], v6 offset:17408
    buffer_store_dwordx4 v[104:107], v23, s[44:47], s68 offen sc1
    global_load_dword v212, v142, s[38:39] offset:-3072
    v_smfmac_f32_16x16x64_bf16 v[32:35], v[80:83], a[8:15], v13
    ds_read_b64_tr_b16 v[76:77], v7 offset:16384
    ds_write_b128 v18, v[52:55] offset:4096
    v_smfmac_f32_16x16x64_bf16 v[36:39], v[80:83], a[8:15], v13 abid:1
    ds_read_b64_tr_b16 v[78:79], v7 offset:17408
    ds_write_b32 v0, v0 offset:1024
    global_load_dword v213, v142, s[38:39] offset:-1024
    v_mul_f32 v96, v40, v112
    v_mul_f32 v97, v41, v114
    v_mul_f32 v98, v42, v116
    v_smfmac_f32_16x16x64_bf16 v[24:27], v[84:87], a[16:23], v11
    global_load_dword v220, v143, s[38:39] offset:-3072
    v_mul_f32 v99, v43, v118
    v_mul_f32 v100, v44, v112
    v_smfmac_f32_16x16x64_bf16 v[28:31], v[84:87], a[16:23], v11 abid:1
    global_load_dword v221, v143, s[38:39] offset:-1024
    v_mul_f32 v101, v45, v114
    v_mul_f32 v102, v46, v116
    v_smfmac_f32_16x16x64_bf16 v[24:27], v[88:91], a[24:31], v11
    ds_read_b64_tr_b16 v[80:81], v6 offset:24576
    v_mul_f32 v103, v47, v118
    v_smfmac_f32_16x16x64_bf16 v[28:31], v[88:91], a[24:31], v11 abid:1
    ds_read_b64_tr_b16 v[82:83], v6 offset:25600
    global_load_dword v214, v142, s[38:39] offset:1024
    v_exp_f32 v96, v96
    v_smfmac_f32_16x16x64_bf16 v[32:35], v[88:91], a[32:39], v13
    ds_read_b64_tr_b16 v[84:85], v7 offset:24576
    global_load_dword v215, v142, s[38:39] offset:3072
    v_exp_f32 v97, v97
    v_exp_f32 v98, v98
    v_smfmac_f32_16x16x64_bf16 v[36:39], v[88:91], a[32:39], v13 abid:1
    ds_read_b64_tr_b16 v[86:87], v7 offset:25600
    global_load_dword v222, v143, s[38:39] offset:1024
    v_exp_f32 v99, v99
    v_smfmac_f32_16x16x64_bf16 v[24:27], v[92:95], a[40:47], v11
    global_load_dword v223, v143, s[38:39] offset:3072
    v_exp_f32 v100, v100
    v_smfmac_f32_16x16x64_bf16 v[28:31], v[92:95], a[40:47], v11 abid:1
    s_waitcnt lgkmcnt(5)
    v_exp_f32 v101, v101
    v_smfmac_f32_16x16x64_bf16 v[24:27], v[72:75], a[48:55], v11
    ds_read_b64_tr_b16 v[88:89], v6 offset:32768
    s_add_u32 s38, s72, 786432
    s_addc_u32 s39, s73, 0
    global_load_dword v224, v142, s[38:39] offset:-4096
    v_exp_f32 v102, v102
    v_smfmac_f32_16x16x64_bf16 v[28:31], v[72:75], a[48:55], v11 abid:1
    ds_read_b64_tr_b16 v[90:91], v6 offset:33792
    global_load_dword v225, v142, s[38:39] offset:-2048
    v_exp_f32 v103, v103
    v_smfmac_f32_16x16x64_bf16 v[32:35], v[72:75], a[56:63], v13
    ds_read_b64_tr_b16 v[92:93], v7 offset:32768
    global_load_dword v232, v143, s[38:39] offset:-4096
    v_fma_f32 v96, v96, v113, v113
    v_fma_f32 v97, v97, v115, v115
    v_smfmac_f32_16x16x64_bf16 v[36:39], v[72:75], a[56:63], v13 abid:1
    ds_read_b64_tr_b16 v[94:95], v7 offset:33792
    global_load_dword v233, v143, s[38:39] offset:-2048
    v_fma_f32 v98, v98, v117, v117
    v_fma_f32 v99, v99, v119, v119
    v_smfmac_f32_16x16x64_bf16 v[24:27], v[76:79], a[64:71], v11
    v_fma_f32 v100, v100, v113, v113
    v_fma_f32 v101, v101, v115, v115
    v_smfmac_f32_16x16x64_bf16 v[28:31], v[76:79], a[64:71], v11 abid:1
    global_load_dword v226, v142, s[38:39] offset:0
    s_waitcnt lgkmcnt(4)
    v_fma_f32 v102, v102, v117, v117
    v_fma_f32 v103, v103, v119, v119
    v_smfmac_f32_16x16x64_bf16 v[24:27], v[80:83], a[72:79], v11
    ds_read_b64_tr_b16 v[72:73], v6 offset:40960
    global_load_dword v227, v142, s[38:39] offset:2048
    v_rcp_f32 v96, v96
    v_smfmac_f32_16x16x64_bf16 v[28:31], v[80:83], a[72:79], v11 abid:1
    ds_read_b64_tr_b16 v[74:75], v6 offset:41984
    global_load_dword v234, v143, s[38:39] offset:0
    v_rcp_f32 v97, v97
    v_smfmac_f32_16x16x64_bf16 v[32:35], v[80:83], a[80:87], v13
    ds_read_b64_tr_b16 v[76:77], v7 offset:40960
    v_rcp_f32 v98, v98
    v_smfmac_f32_16x16x64_bf16 v[36:39], v[80:83], a[80:87], v13 abid:1
    ds_read_b64_tr_b16 v[78:79], v7 offset:41984
    global_load_dword v235, v143, s[38:39] offset:2048
    v_rcp_f32 v99, v99
    v_smfmac_f32_16x16x64_bf16 v[24:27], v[84:87], a[88:95], v11
    global_load_dword v228, v142, s[38:39] offset:-3072
    v_rcp_f32 v100, v100
    v_smfmac_f32_16x16x64_bf16 v[28:31], v[84:87], a[88:95], v11 abid:1
    global_load_dword v229, v142, s[38:39] offset:-1024
    s_waitcnt lgkmcnt(4)
    v_rcp_f32 v101, v101
    v_smfmac_f32_16x16x64_bf16 v[24:27], v[88:91], a[96:103], v11
    ds_read_b64_tr_b16 v[80:81], v6 offset:49152
    global_load_dword v236, v143, s[38:39] offset:-3072
    v_rcp_f32 v102, v102
    v_smfmac_f32_16x16x64_bf16 v[28:31], v[88:91], a[96:103], v11 abid:1
    ds_read_b64_tr_b16 v[82:83], v6 offset:50176
    ds_read_b32 v121, v1 offset:1024
    ds_read_b128 v[108:111], v19 offset:4096
    v_rcp_f32 v103, v103
    v_mul_f32 v96, v96, v40
    v_smfmac_f32_16x16x64_bf16 v[32:35], v[88:91], a[104:111], v13
    ds_read_b64_tr_b16 v[84:85], v7 offset:49152
    global_load_dword v237, v143, s[38:39] offset:-1024
    v_mul_f32 v97, v97, v41
    v_mul_f32 v98, v98, v42
    v_smfmac_f32_16x16x64_bf16 v[36:39], v[88:91], a[104:111], v13 abid:1
    ds_read_b64_tr_b16 v[86:87], v7 offset:50176
    global_load_dword v230, v142, s[38:39] offset:1024
    v_mul_f32 v99, v99, v43
    v_mul_f32 v100, v100, v44
    v_smfmac_f32_16x16x64_bf16 v[24:27], v[92:95], a[112:119], v11
    global_load_dword v231, v142, s[38:39] offset:3072
    v_mul_f32 v101, v101, v45
    v_mul_f32 v102, v102, v46
    v_smfmac_f32_16x16x64_bf16 v[28:31], v[92:95], a[112:119], v11 abid:1
    s_waitcnt lgkmcnt(6)
    v_mul_f32 v103, v103, v47
    v_cvt_pk_bf16_f32 v96, v96, v97
    v_smfmac_f32_16x16x64_bf16 v[24:27], v[72:75], a[120:127], v11
    ds_read_b64_tr_b16 v[88:89], v6 offset:57344
    global_load_dword v238, v143, s[38:39] offset:1024
    s_waitcnt lgkmcnt(3)
    v_cmp_eq_u32 vcc, 0, v121
    s_cbranch_vccnz FL_R1
FL_C1:
    v_cvt_pk_bf16_f32 v97, v98, v99
    v_cvt_pk_bf16_f32 v100, v100, v101
    v_smfmac_f32_16x16x64_bf16 v[28:31], v[72:75], a[120:127], v11 abid:1
    ds_read_b64_tr_b16 v[90:91], v6 offset:58368
    ds_write_b64 v14, v[96:97]
    global_load_dword v239, v143, s[38:39] offset:3072
    v_cvt_pk_bf16_f32 v101, v102, v103
    v_add_f32 v48, v48, v108
    v_smfmac_f32_16x16x64_bf16 v[32:35], v[72:75], a[128:135], v13
    ds_read_b64_tr_b16 v[92:93], v7 offset:57344
    ds_write_b64 v14, v[100:101] offset:128
    s_add_u32 s38, s74, 0
    s_addc_u32 s39, s75, 0
    global_load_dword v240, v142, s[38:39] offset:-4096
    v_add_f32 v49, v49, v109
    v_add_f32 v50, v50, v110
    v_smfmac_f32_16x16x64_bf16 v[36:39], v[72:75], a[128:135], v13 abid:1
    ds_read_b64_tr_b16 v[94:95], v7 offset:58368
    ds_read_b64_tr_b16 v[100:101], v15
    global_load_dword v241, v142, s[38:39] offset:-2048
    v_add_f32 v51, v51, v111
    v_mul_f32 v104, v48, v112
    v_smfmac_f32_16x16x64_bf16 v[24:27], v[76:79], a[136:143], v11
    ds_read_b64_tr_b16 v[102:103], v15 offset:576
    ds_read_b32 v12, v21 offset:192
    v_mul_f32 v105, v49, v114
    v_mul_f32 v106, v50, v116
    v_smfmac_f32_16x16x64_bf16 v[28:31], v[76:79], a[136:143], v11 abid:1
    global_load_dword v248, v143, s[38:39] offset:-4096
    s_waitcnt lgkmcnt(9)
    v_mul_f32 v107, v51, v118
    v_exp_f32 v104, v104
    v_smfmac_f32_16x16x64_bf16 v[24:27], v[80:83], a[144:151], v11
    ds_read_b64_tr_b16 v[72:73], v8 offset:0
    global_load_dword v249, v143, s[38:39] offset:-2048
    v_exp_f32 v105, v105
    v_smfmac_f32_16x16x64_bf16 v[28:31], v[80:83], a[144:151], v11 abid:1
    ds_read_b64_tr_b16 v[74:75], v8 offset:1024
    global_load_dword v242, v142, s[38:39] offset:0
    v_exp_f32 v106, v106
    v_smfmac_f32_16x16x64_bf16 v[32:35], v[80:83], a[152:159], v13
    ds_read_b64_tr_b16 v[76:77], v9 offset:0
    global_load_dword v243, v142, s[38:39] offset:2048
    v_exp_f32 v107, v107
    v_smfmac_f32_16x16x64_bf16 v[36:39], v[80:83], a[152:159], v13 abid:1
    ds_read_b64_tr_b16 v[78:79], v9 offset:1024
    v_fma_f32 v104, v104, v113, v113
    v_fma_f32 v105, v105, v115, v115
    v_smfmac_f32_16x16x64_bf16 v[24:27], v[84:87], a[160:167], v11
    ds_read_b128 v[64:67], v20 offset:256
    global_load_dword v250, v143, s[38:39] offset:0
    s_waitcnt lgkmcnt(6)
    s_mov_b32 s68, 45056
    v_fma_f32 v106, v106, v117, v117
    v_fma_f32 v107, v107, v119, v119
    v_smfmac_f32_16x16x64_bf16 v[28:31], v[84:87], a[160:167], v11 abid:1
    buffer_store_dwordx4 v[100:103], v22, s[44:47], s68 offen sc1
    ds_read_b128 v[68:71], v20 offset:272
    global_load_dword v251, v143, s[38:39] offset:2048
    v_rcp_f32 v104, v104
    v_smfmac_f32_16x16x64_bf16 v[24:27], v[88:91], a[168:175], v11
    ds_read_b64_tr_b16 v[80:81], v8 offset:8192
    global_load_dword v244, v142, s[38:39] offset:-3072
    v_rcp_f32 v105, v105
    v_smfmac_f32_16x16x64_bf16 v[28:31], v[88:91], a[168:175], v11 abid:1
    ds_read_b64_tr_b16 v[82:83], v8 offset:9216
    v_rcp_f32 v106, v106
    v_smfmac_f32_16x16x64_bf16 v[32:35], v[88:91], a[176:183], v13
    ds_read_b64_tr_b16 v[84:85], v9 offset:8192
    global_load_dword v245, v142, s[38:39] offset:-1024
    v_rcp_f32 v107, v107
    v_smfmac_f32_16x16x64_bf16 v[36:39], v[88:91], a[176:183], v13 abid:1
    ds_read_b64_tr_b16 v[86:87], v9 offset:9216
    global_load_dword v252, v143, s[38:39] offset:-3072
    v_mul_f32 v104, v104, v48
    v_mul_f32 v105, v105, v49
    v_smfmac_f32_16x16x64_bf16 v[24:27], v[92:95], a[184:191], v11
    global_load_dword v253, v143, s[38:39] offset:-1024
    v_mul_f32 v106, v106, v50
    v_mul_f32 v107, v107, v51
    v_smfmac_f32_16x16x64_bf16 v[28:31], v[92:95], a[184:191], v11 abid:1
    global_load_dword v246, v142, s[38:39] offset:1024
    s_waitcnt lgkmcnt(6)
    v_cvt_pk_bf16_f32 v104, v104, v105
    v_cvt_pk_bf16_f32 v105, v106, v107
    v_mfma_f32_16x16x16_bf16 v[52:55], v[12:13], v[62:63], 0
    ds_write_b64 v16, v[104:105]
    v_mfma_f32_16x16x16_bf16 v[40:43], v[12:13], v[56:57], 0
    ds_read_b64_tr_b16 v[104:105], v17
    global_load_dword v247, v142, s[38:39] offset:3072
    v_mfma_f32_16x16x16_bf16 v[44:47], v[12:13], v[58:59], 0
    ds_read_b64_tr_b16 v[106:107], v17 offset:192
    global_load_dword v254, v143, s[38:39] offset:1024
    v_mfma_f32_16x16x16_bf16 v[48:51], v[12:13], v[60:61], 0
    global_load_dword v255, v143, s[38:39] offset:3072
    v_smfmac_f32_16x16x64_bf16 v[40:43], v[72:75], a[0:7], v11
    ds_read_b64_tr_b16 v[88:89], v8 offset:16384
    ds_write_b128 v18, v[36:39] offset:0
    v_smfmac_f32_16x16x64_bf16 v[44:47], v[72:75], a[0:7], v11 abid:1
    ds_read_b64_tr_b16 v[90:91], v8 offset:17408
    ds_write_b32 v0, v0 offset:2048
    s_waitcnt lgkmcnt(12)
    v_mul_f32 v96, v24, v64
    v_mul_f32 v97, v25, v66
    s_waitcnt lgkmcnt(11)
    v_mul_f32 v98, v26, v68
    v_smfmac_f32_16x16x64_bf16 v[48:51], v[72:75], a[8:15], v13
    ds_read_b64_tr_b16 v[92:93], v9 offset:16384
    v_mul_f32 v99, v27, v70
    v_mul_f32 v100, v28, v64
    v_smfmac_f32_16x16x64_bf16 v[52:55], v[72:75], a[8:15], v13 abid:1
    ds_read_b64_tr_b16 v[94:95], v9 offset:17408
    v_mul_f32 v101, v29, v66
    v_mul_f32 v102, v30, v68
    v_mul_f32 v103, v31, v70
    v_smfmac_f32_16x16x64_bf16 v[40:43], v[76:79], a[16:23], v11
    s_waitcnt lgkmcnt(6)
    v_exp_f32 v96, v96
    v_smfmac_f32_16x16x64_bf16 v[44:47], v[76:79], a[16:23], v11 abid:1
    buffer_store_dwordx4 v[104:107], v23, s[44:47], s68 offen sc1
    v_exp_f32 v97, v97
    v_smfmac_f32_16x16x64_bf16 v[40:43], v[80:83], a[24:31], v11
    ds_read_b64_tr_b16 v[72:73], v8 offset:24576
    v_exp_f32 v98, v98
    v_smfmac_f32_16x16x64_bf16 v[44:47], v[80:83], a[24:31], v11 abid:1
    ds_read_b64_tr_b16 v[74:75], v8 offset:25600
    v_exp_f32 v99, v99
    v_exp_f32 v100, v100
    v_smfmac_f32_16x16x64_bf16 v[48:51], v[80:83], a[32:39], v13
    ds_read_b64_tr_b16 v[76:77], v9 offset:24576
    v_exp_f32 v101, v101
    v_smfmac_f32_16x16x64_bf16 v[52:55], v[80:83], a[32:39], v13 abid:1
    ds_read_b64_tr_b16 v[78:79], v9 offset:25600
    v_exp_f32 v102, v102
    v_smfmac_f32_16x16x64_bf16 v[40:43], v[84:87], a[40:47], v11
    v_exp_f32 v103, v103
    v_fma_f32 v96, v96, v65, v65
    v_smfmac_f32_16x16x64_bf16 v[44:47], v[84:87], a[40:47], v11 abid:1
    s_waitcnt lgkmcnt(4)
    v_fma_f32 v97, v97, v67, v67
    v_fma_f32 v98, v98, v69, v69
    v_smfmac_f32_16x16x64_bf16 v[40:43], v[88:91], a[48:55], v11
    ds_read_b64_tr_b16 v[80:81], v8 offset:32768
    v_fma_f32 v99, v99, v71, v71
    v_fma_f32 v100, v100, v65, v65
    v_smfmac_f32_16x16x64_bf16 v[44:47], v[88:91], a[48:55], v11 abid:1
    ds_read_b64_tr_b16 v[82:83], v8 offset:33792
    v_fma_f32 v101, v101, v67, v67
    v_fma_f32 v102, v102, v69, v69
    v_fma_f32 v103, v103, v71, v71
    v_smfmac_f32_16x16x64_bf16 v[48:51], v[88:91], a[56:63], v13
    ds_read_b64_tr_b16 v[84:85], v9 offset:32768
    v_rcp_f32 v96, v96
    v_smfmac_f32_16x16x64_bf16 v[52:55], v[88:91], a[56:63], v13 abid:1
    ds_read_b64_tr_b16 v[86:87], v9 offset:33792
    v_rcp_f32 v97, v97
    v_smfmac_f32_16x16x64_bf16 v[40:43], v[92:95], a[64:71], v11
    s_mov_b32 s60, 0
    buffer_load_dwordx4 a[0:3], v130, s[44:47], s60 offen offset:0 sc1
    v_rcp_f32 v98, v98
    v_rcp_f32 v99, v99
    v_smfmac_f32_16x16x64_bf16 v[44:47], v[92:95], a[64:71], v11 abid:1
    buffer_load_dwordx4 a[4:7], v130, s[44:47], s60 offen offset:1024 sc1
    s_waitcnt lgkmcnt(4)
    v_rcp_f32 v100, v100
    v_smfmac_f32_16x16x64_bf16 v[40:43], v[72:75], a[72:79], v11
    ds_read_b64_tr_b16 v[88:89], v8 offset:40960
    v_rcp_f32 v101, v101
    v_smfmac_f32_16x16x64_bf16 v[44:47], v[72:75], a[72:79], v11 abid:1
    ds_read_b64_tr_b16 v[90:91], v8 offset:41984
    ds_read_b32 v121, v1 offset:2048
    ds_read_b128 v[108:111], v19 offset:0
    v_rcp_f32 v102, v102
    v_smfmac_f32_16x16x64_bf16 v[48:51], v[72:75], a[80:87], v13
    ds_read_b64_tr_b16 v[92:93], v9 offset:40960
    v_rcp_f32 v103, v103
    v_mul_f32 v96, v96, v24
    v_smfmac_f32_16x16x64_bf16 v[52:55], v[72:75], a[80:87], v13 abid:1
    ds_read_b64_tr_b16 v[94:95], v9 offset:41984
    v_mul_f32 v97, v97, v25
    v_mul_f32 v98, v98, v26
    v_smfmac_f32_16x16x64_bf16 v[40:43], v[76:79], a[88:95], v11
    buffer_load_dwordx4 a[8:11], v130, s[44:47], s60 offen offset:2048 sc1
    v_mul_f32 v99, v99, v27
    v_mul_f32 v100, v100, v28
    v_mul_f32 v101, v101, v29
    v_smfmac_f32_16x16x64_bf16 v[44:47], v[76:79], a[88:95], v11 abid:1
    buffer_load_dwordx4 a[12:15], v130, s[44:47], s60 offen offset:3072 sc1
    s_waitcnt lgkmcnt(6)
    v_mul_f32 v102, v102, v30
    v_mul_f32 v103, v103, v31
    v_smfmac_f32_16x16x64_bf16 v[40:43], v[80:83], a[96:103], v11
    ds_read_b64_tr_b16 v[72:73], v8 offset:49152
    s_waitcnt lgkmcnt(3)
    v_cmp_eq_u32 vcc, 0, v121
    s_cbranch_vccnz FL_R2
FL_C2:
    v_cvt_pk_bf16_f32 v96, v96, v97
    v_cvt_pk_bf16_f32 v97, v98, v99
    v_smfmac_f32_16x16x64_bf16 v[44:47], v[80:83], a[96:103], v11 abid:1
    ds_read_b64_tr_b16 v[74:75], v8 offset:50176
    ds_write_b64 v14, v[96:97]
    v_cvt_pk_bf16_f32 v100, v100, v101
    v_cvt_pk_bf16_f32 v101, v102, v103
    v_add_f32 v32, v32, v108
    v_smfmac_f32_16x16x64_bf16 v[48:51], v[80:83], a[104:111], v13
    ds_read_b64_tr_b16 v[76:77], v9 offset:49152
    ds_write_b64 v14, v[100:101] offset:128
    v_add_f32 v33, v33, v109
    v_add_f32 v34, v34, v110
    v_smfmac_f32_16x16x64_bf16 v[52:55], v[80:83], a[104:111], v13 abid:1
    ds_read_b64_tr_b16 v[78:79], v9 offset:50176
    ds_read_b64_tr_b16 v[100:101], v15
    v_add_f32 v35, v35, v111
    v_mul_f32 v104, v32, v64
    v_mul_f32 v105, v33, v66
    v_smfmac_f32_16x16x64_bf16 v[40:43], v[84:87], a[112:119], v11
    ds_read_b64_tr_b16 v[102:103], v15 offset:576
    s_mov_b32 s60, 4096
    buffer_load_dwordx4 a[16:19], v130, s[44:47], s60 offen offset:0 sc1
    v_mul_f32 v106, v34, v68
    v_mul_f32 v107, v35, v70
    v_smfmac_f32_16x16x64_bf16 v[44:47], v[84:87], a[112:119], v11 abid:1
    buffer_load_dwordx4 a[20:23], v130, s[44:47], s60 offen offset:1024 sc1
    s_waitcnt lgkmcnt(8)
    v_exp_f32 v104, v104
    v_smfmac_f32_16x16x64_bf16 v[40:43], v[88:91], a[120:127], v11
    ds_read_b64_tr_b16 v[80:81], v8 offset:57344
    v_xor_b32 v135, 0, v137
    v_exp_f32 v105, v105
    v_smfmac_f32_16x16x64_bf16 v[44:47], v[88:91], a[120:127], v11 abid:1
    ds_read_b64_tr_b16 v[82:83], v8 offset:58368
    ds_read2_b32 v[138:139], v135 offset1:32
    v_exp_f32 v106, v106
    v_exp_f32 v107, v107
    v_smfmac_f32_16x16x64_bf16 v[48:51], v[88:91], a[128:135], v13
    ds_read_b64_tr_b16 v[84:85], v9 offset:57344
    v_fma_f32 v104, v104, v65, v65
    v_fma_f32 v105, v105, v67, v67
    v_smfmac_f32_16x16x64_bf16 v[52:55], v[88:91], a[128:135], v13 abid:1
    ds_read_b64_tr_b16 v[86:87], v9 offset:58368
    v_fma_f32 v106, v106, v69, v69
    v_fma_f32 v107, v107, v71, v71
    v_smfmac_f32_16x16x64_bf16 v[40:43], v[92:95], a[136:143], v11
    ds_read_b128 v[112:115], v20 offset:384
    buffer_load_dwordx4 a[24:27], v130, s[44:47], s60 offen offset:2048 sc1
    s_waitcnt lgkmcnt(6)
    s_mov_b32 s68, 90112
    v_rcp_f32 v104, v104
    v_smfmac_f32_16x16x64_bf16 v[44:47], v[92:95], a[136:143], v11 abid:1
    buffer_store_dwordx4 v[100:103], v22, s[44:47], s68 offen sc1
    ds_read_b128 v[116:119], v20 offset:400
    buffer_load_dwordx4 a[28:31], v130, s[44:47], s60 offen offset:3072 sc1
    v_rcp_f32 v105, v105
    v_smfmac_f32_16x16x64_bf16 v[40:43], v[72:75], a[144:151], v11
    s_mov_b32 s60, 8192
    buffer_load_dwordx4 a[32:35], v130, s[44:47], s60 offen offset:0 sc1
    v_rcp_f32 v106, v106
    v_rcp_f32 v107, v107
    v_smfmac_f32_16x16x64_bf16 v[44:47], v[72:75], a[144:151], v11 abid:1
    buffer_load_dwordx4 a[36:39], v130, s[44:47], s60 offen offset:1024 sc1
    v_mul_f32 v104, v104, v32
    v_mul_f32 v105, v105, v33
    v_smfmac_f32_16x16x64_bf16 v[48:51], v[72:75], a[152:159], v13
    s_add_u32 s60, s60, s78
    buffer_load_dwordx4 a[40:43], v130, s[44:47], s60 offen offset:2048 sc1
    v_mul_f32 v106, v106, v34
    v_mul_f32 v107, v107, v35
    v_smfmac_f32_16x16x64_bf16 v[52:55], v[72:75], a[152:159], v13 abid:1
    s_waitcnt lgkmcnt(4)
    v_cvt_pk_bf16_f32 v104, v104, v105
    v_cvt_pk_bf16_f32 v105, v106, v107
    v_smfmac_f32_16x16x64_bf16 v[40:43], v[76:79], a[160:167], v11
    ds_write_b64 v16, v[104:105]
    v_lshlrev_b32 v24, 16, v138
    v_and_b32 v25, 0xffff0000, v138
    v_smfmac_f32_16x16x64_bf16 v[44:47], v[76:79], a[160:167], v11 abid:1
    ds_read_b64_tr_b16 v[104:105], v17
    s_waitcnt lgkmcnt(4)
    v_lshlrev_b32 v28, 16, v139
    v_and_b32 v29, 0xffff0000, v139
    v_smfmac_f32_16x16x64_bf16 v[40:43], v[80:83], a[168:175], v11
    ds_read_b64_tr_b16 v[106:107], v17 offset:192
    v_mov_b32 v26, 0
    v_mov_b32 v27, 0
    v_smfmac_f32_16x16x64_bf16 v[44:47], v[80:83], a[168:175], v11 abid:1
    v_mov_b32 v30, 0
    v_mov_b32 v31, 0
    v_smfmac_f32_16x16x64_bf16 v[48:51], v[80:83], a[176:183], v13
    v_mov_b32 v32, 0
    v_mov_b32 v33, 0
    v_smfmac_f32_16x16x64_bf16 v[52:55], v[80:83], a[176:183], v13 abid:1
    v_mov_b32 v34, 0
    v_mov_b32 v35, 0
    v_smfmac_f32_16x16x64_bf16 v[40:43], v[84:87], a[184:191], v11
    v_mov_b32 v36, 0
    v_mov_b32 v37, 0
    v_smfmac_f32_16x16x64_bf16 v[44:47], v[84:87], a[184:191], v11 abid:1
    s_waitcnt vmcnt(11)
    v_mov_b32 v38, 0
    v_mov_b32 v39, 0
    v_smfmac_f32_16x16x64_bf16 v[24:27], a[0:3], a[192:199], v11
    s_waitcnt lgkmcnt(0)
    v_smfmac_f32_16x16x64_bf16 v[28:31], a[0:3], a[192:199], v11 abid:1
    buffer_store_dwordx4 v[104:107], v23, s[44:47], s68 offen sc1
    ds_write_b128 v18, v[52:55] offset:4096
    s_mov_b32 s60, 45056
    buffer_load_dwordx4 a[44:47], v130, s[44:47], s60 offen offset:0 sc1
    v_smfmac_f32_16x16x64_bf16 v[32:35], a[0:3], a[200:207], v11
    ds_write_b32 v0, v0 offset:3072
    v_mul_f32 v96, v40, v112
    v_mul_f32 v97, v41, v114
    v_mul_f32 v98, v42, v116
    v_smfmac_f32_16x16x64_bf16 v[36:39], a[0:3], a[200:207], v11 abid:1
    s_waitcnt vmcnt(12)
    v_mul_f32 v99, v43, v118
    v_mul_f32 v100, v44, v112
    v_mul_f32 v101, v45, v114
    v_smfmac_f32_16x16x64_bf16 v[24:27], a[4:7], a[208:215], v11
    v_mul_f32 v102, v46, v116
    v_mul_f32 v103, v47, v118
    v_exp_f32 v96, v96
    v_smfmac_f32_16x16x64_bf16 v[28:31], a[4:7], a[208:215], v11 abid:1
    buffer_load_dwordx4 a[48:51], v130, s[44:47], s60 offen offset:1024 sc1
    v_exp_f32 v97, v97
    v_smfmac_f32_16x16x64_bf16 v[32:35], a[4:7], a[216:223], v11
    v_exp_f32 v98, v98
    v_smfmac_f32_16x16x64_bf16 v[36:39], a[4:7], a[216:223], v11 abid:1
    s_waitcnt vmcnt(12)
    v_exp_f32 v99, v99
    v_exp_f32 v100, v100
    v_smfmac_f32_16x16x64_bf16 v[24:27], a[8:11], a[224:231], v11
    v_exp_f32 v101, v101
    s_branch PO_5
.p2align 12
PG_5:
    s_branch HOP_B
PO_5:
    v_smfmac_f32_16x16x64_bf16 v[28:31], a[8:11], a[224:231], v11 abid:1
    buffer_load_dwordx4 a[52:55], v130, s[44:47], s60 offen offset:2048 sc1
    v_exp_f32 v102, v102
    v_exp_f32 v103, v103
    v_smfmac_f32_16x16x64_bf16 v[32:35], a[8:11], a[232:239], v11
    v_fma_f32 v96, v96, v113, v113
    v_fma_f32 v97, v97, v115, v115
    v_smfmac_f32_16x16x64_bf16 v[36:39], a[8:11], a[232:239], v11 abid:1
    s_waitcnt vmcnt(12)
    v_fma_f32 v98, v98, v117, v117
    v_fma_f32 v99, v99, v119, v119
    v_fma_f32 v100, v100, v113, v113
    v_smfmac_f32_16x16x64_bf16 v[24:27], a[12:15], a[240:247], v11
    v_fma_f32 v101, v101, v115, v115
    v_fma_f32 v102, v102, v117, v117
    v_fma_f32 v103, v103, v119, v119
    v_smfmac_f32_16x16x64_bf16 v[28:31], a[12:15], a[240:247], v11 abid:1
    buffer_load_dwordx4 a[56:59], v130, s[44:47], s60 offen offset:3072 sc1
    v_rcp_f32 v96, v96
    v_smfmac_f32_16x16x64_bf16 v[32:35], a[12:15], a[248:255], v11
    v_rcp_f32 v97, v97
    v_rcp_f32 v98, v98
    v_smfmac_f32_16x16x64_bf16 v[36:39], a[12:15], a[248:255], v11 abid:1
    s_waitcnt vmcnt(12)
    v_rcp_f32 v99, v99
    v_smfmac_f32_16x16x64_bf16 v[24:27], a[16:19], v[144:151], v11
    v_rcp_f32 v100, v100
    v_rcp_f32 v101, v101
    v_smfmac_f32_16x16x64_bf16 v[28:31], a[16:19], v[144:151], v11 abid:1
    ds_read_b32 v121, v1 offset:3072
    ds_read_b128 v[108:111], v19 offset:4096
    s_mov_b32 s60, 49152
    buffer_load_dwordx4 a[60:63], v130, s[44:47], s60 offen offset:0 sc1
    v_rcp_f32 v102, v102
    v_smfmac_f32_16x16x64_bf16 v[32:35], a[16:19], v[152:159], v11
    v_rcp_f32 v103, v103
    v_mul_f32 v96, v96, v40
    v_smfmac_f32_16x16x64_bf16 v[36:39], a[16:19], v[152:159], v11 abid:1
    s_waitcnt vmcnt(12)
    v_mul_f32 v97, v97, v41
    v_mul_f32 v98, v98, v42
    v_mul_f32 v99, v99, v43
    v_smfmac_f32_16x16x64_bf16 v[24:27], a[20:23], v[160:167], v11
    v_mul_f32 v100, v100, v44
    v_mul_f32 v101, v101, v45
    v_mul_f32 v102, v102, v46
    v_smfmac_f32_16x16x64_bf16 v[28:31], a[20:23], v[160:167], v11 abid:1
    buffer_load_dwordx4 a[64:67], v130, s[44:47], s60 offen offset:1024 sc1
    v_mul_f32 v103, v103, v47
    v_cvt_pk_bf16_f32 v96, v96, v97
    v_smfmac_f32_16x16x64_bf16 v[32:35], a[20:23], v[168:175], v11
    s_waitcnt lgkmcnt(0)
    v_cmp_eq_u32 vcc, 0, v121
    s_cbranch_vccnz FL_R3
FL_C3:
    v_cvt_pk_bf16_f32 v97, v98, v99
    v_cvt_pk_bf16_f32 v100, v100, v101
    v_cvt_pk_bf16_f32 v101, v102, v103
    v_smfmac_f32_16x16x64_bf16 v[36:39], a[20:23], v[168:175], v11 abid:1
    ds_write_b64 v14, v[96:97]
    ds_write_b64 v14, v[100:101] offset:128
    v_add_f32 v48, v48, v108
    v_add_f32 v49, v49, v109
    v_add_f32 v50, v50, v110
    s_waitcnt vmcnt(12)
    v_smfmac_f32_16x16x64_bf16 v[24:27], a[24:27], v[176:183], v11
    ds_read_b64_tr_b16 v[100:101], v15
    v_add_f32 v51, v51, v111
    v_mul_f32 v104, v48, v112
    v_mul_f32 v105, v49, v114
    v_xor_b32 v135, 32, v137
    v_smfmac_f32_16x16x64_bf16 v[28:31], a[24:27], v[176:183], v11 abid:1
    ds_read_b64_tr_b16 v[102:103], v15 offset:576
    ds_read2_b32 v[138:139], v135 offset1:32
    buffer_load_dwordx4 a[68:71], v130, s[44:47], s60 offen offset:2048 sc1
    v_mul_f32 v106, v50, v116
    v_mul_f32 v107, v51, v118
    v_smfmac_f32_16x16x64_bf16 v[32:35], a[24:27], v[184:191], v11
    v_exp_f32 v104, v104
    v_exp_f32 v105, v105
    v_smfmac_f32_16x16x64_bf16 v[36:39], a[24:27], v[184:191], v11 abid:1
    s_waitcnt vmcnt(11)
    v_exp_f32 v106, v106
    v_smfmac_f32_16x16x64_bf16 v[24:27], a[28:31], v[192:199], v11
    v_exp_f32 v107, v107
    v_fma_f32 v104, v104, v113, v113
    v_smfmac_f32_16x16x64_bf16 v[28:31], a[28:31], v[192:199], v11 abid:1
    buffer_load_dwordx4 a[72:75], v130, s[44:47], s60 offen offset:3072 sc1
    v_fma_f32 v105, v105, v115, v115
    v_fma_f32 v106, v106, v117, v117
    v_fma_f32 v107, v107, v119, v119
    v_smfmac_f32_16x16x64_bf16 v[32:35], a[28:31], v[200:207], v11
    v_rcp_f32 v104, v104
    v_rcp_f32 v105, v105
    v_smfmac_f32_16x16x64_bf16 v[36:39], a[28:31], v[200:207], v11 abid:1
    s_waitcnt lgkmcnt(1)
    s_mov_b32 s68, 135168
    v_rcp_f32 v106, v106
    s_waitcnt vmcnt(11)
    v_smfmac_f32_16x16x64_bf16 v[24:27], a[32:35], v[208:215], v11
    buffer_store_dwordx4 v[100:103], v22, s[44:47], s68 offen sc1
    v_rcp_f32 v107, v107
    v_mul_f32 v104, v104, v48
    v_smfmac_f32_16x16x64_bf16 v[28:31], a[32:35], v[208:215], v11 abid:1
    s_mov_b32 s60, 53248
    buffer_load_dwordx4 a[76:79], v130, s[44:47], s60 offen offset:0 sc1
    v_mul_f32 v105, v105, v49
    v_mul_f32 v106, v106, v50
    v_mul_f32 v107, v107, v51
    v_smfmac_f32_16x16x64_bf16 v[32:35], a[32:35], v[216:223], v11
    s_waitcnt lgkmcnt(0)
    v_cvt_pk_bf16_f32 v104, v104, v105
    v_cvt_pk_bf16_f32 v105, v106, v107
    v_smfmac_f32_16x16x64_bf16 v[36:39], a[32:35], v[216:223], v11 abid:1
    ds_write_b64 v16, v[104:105]
    v_lshlrev_b32 v72, 16, v138
    v_and_b32 v73, 0xffff0000, v138
    s_waitcnt vmcnt(12)
    v_smfmac_f32_16x16x64_bf16 v[24:27], a[36:39], v[224:231], v11
    ds_read_b64_tr_b16 v[104:105], v17
    v_lshlrev_b32 v76, 16, v139
    v_and_b32 v77, 0xffff0000, v139
    v_smfmac_f32_16x16x64_bf16 v[28:31], a[36:39], v[224:231], v11 abid:1
    ds_read_b64_tr_b16 v[106:107], v17 offset:192
    buffer_load_dwordx4 a[80:83], v130, s[44:47], s60 offen offset:1024 sc1
    v_mov_b32 v74, 0
    v_mov_b32 v75, 0
    v_smfmac_f32_16x16x64_bf16 v[32:35], a[36:39], v[232:239], v11
    v_mov_b32 v78, 0
    v_mov_b32 v79, 0
    v_smfmac_f32_16x16x64_bf16 v[36:39], a[36:39], v[232:239], v11 abid:1
    s_waitcnt vmcnt(12)
    v_mov_b32 v80, 0
    v_smfmac_f32_16x16x64_bf16 v[24:27], a[40:43], v[240:247], v11
    v_mov_b32 v81, 0
    v_mov_b32 v82, 0
    v_smfmac_f32_16x16x64_bf16 v[28:31], a[40:43], v[240:247], v11 abid:1
    s_add_u32 s60, s60, s78
    buffer_load_dwordx4 a[84:87], v130, s[44:47], s60 offen offset:2048 sc1
    v_mov_b32 v83, 0
    v_mov_b32 v84, 0
    v_smfmac_f32_16x16x64_bf16 v[32:35], a[40:43], v[248:255], v11
    v_mov_b32 v85, 0
    v_mov_b32 v86, 0
    v_smfmac_f32_16x16x64_bf16 v[36:39], a[40:43], v[248:255], v11 abid:1
    s_waitcnt lgkmcnt(0)
    v_mov_b32 v87, 0
    s_waitcnt vmcnt(11)
    v_smfmac_f32_16x16x64_bf16 v[72:75], a[44:47], a[192:199], v11
    buffer_store_dwordx4 v[104:107], v23, s[44:47], s68 offen sc1
    v_smfmac_f32_16x16x64_bf16 v[76:79], a[44:47], a[192:199], v11 abid:1
    s_mov_b32 s60, 90112
    buffer_load_dwordx4 a[88:91], v130, s[44:47], s60 offen offset:0 sc1
    v_smfmac_f32_16x16x64_bf16 v[80:83], a[44:47], a[200:207], v11
    v_cmp_u_f32 vcc, v24, v25
    v_cmp_u_f32 s[62:63], v26, v27
    v_smfmac_f32_16x16x64_bf16 v[84:87], a[44:47], a[200:207], v11 abid:1
    s_or_b64 vcc, vcc, s[62:63]
    s_cbranch_scc1 G2_R0
G2_C0:
    s_waitcnt vmcnt(12)
    v_smfmac_f32_16x16x64_bf16 v[72:75], a[48:51], a[208:215], v11
    ds_write2st64_b64 v131, v[26:27], v[30:31] offset0:0 offset1:1
    v_smfmac_f32_16x16x64_bf16 v[76:79], a[48:51], a[208:215], v11 abid:1
    buffer_load_dwordx4 a[92:95], v130, s[44:47], s60 offen offset:1024 sc1
    v_smfmac_f32_16x16x64_bf16 v[80:83], a[48:51], a[216:223], v11
    ds_write2st64_b64 v132, v[32:33], v[36:37] offset0:8 offset1:9
    v_smfmac_f32_16x16x64_bf16 v[84:87], a[48:51], a[216:223], v11 abid:1
    s_waitcnt vmcnt(12)
    v_smfmac_f32_16x16x64_bf16 v[72:75], a[52:55], a[224:231], v11
    ds_write2st64_b64 v133, v[34:35], v[38:39] offset0:16 offset1:17
    v_smfmac_f32_16x16x64_bf16 v[76:79], a[52:55], a[224:231], v11 abid:1
    buffer_load_dwordx4 a[96:99], v130, s[44:47], s60 offen offset:2048 sc1
    v_smfmac_f32_16x16x64_bf16 v[80:83], a[52:55], a[232:239], v11
    v_xor_b32 v135, 64, v137
    v_smfmac_f32_16x16x64_bf16 v[84:87], a[52:55], a[232:239], v11 abid:1
    ds_read2_b32 v[138:139], v135 offset1:32
    v_mov_b32 v32, 0
    s_waitcnt vmcnt(12)
    v_smfmac_f32_16x16x64_bf16 v[72:75], a[56:59], a[240:247], v11
    s_waitcnt lgkmcnt(1)
    s_barrier
    v_mov_b32 v33, 0
    v_smfmac_f32_16x16x64_bf16 v[76:79], a[56:59], a[240:247], v11 abid:1
    buffer_load_dwordx4 a[100:103], v130, s[44:47], s60 offen offset:3072 sc1
    ds_read2st64_b64 v[96:99], v134 offset0:0 offset1:1
    v_mov_b32 v34, 0
    v_smfmac_f32_16x16x64_bf16 v[80:83], a[56:59], a[248:255], v11
    ds_read2st64_b64 v[100:103], v134 offset0:8 offset1:9
    s_add_u32 s76, s24, 0
    s_addc_u32 s77, s25, 0
    v_mov_b32 v35, 0
    v_smfmac_f32_16x16x64_bf16 v[84:87], a[56:59], a[248:255], v11 abid:1
    ds_read2st64_b64 v[104:107], v134 offset0:16 offset1:17
    s_waitcnt vmcnt(12)
    v_smfmac_f32_16x16x64_bf16 v[72:75], a[60:63], v[144:151], v11
    v_mov_b32 v36, 0
    v_smfmac_f32_16x16x64_bf16 v[76:79], a[60:63], v[144:151], v11 abid:1
    s_mov_b32 s60, 94208
    buffer_load_dwordx4 a[104:107], v130, s[44:47], s60 offen offset:0 sc1
    v_mov_b32 v37, 0
    v_smfmac_f32_16x16x64_bf16 v[80:83], a[60:63], v[152:159], v11
    v_mov_b32 v38, 0
    v_smfmac_f32_16x16x64_bf16 v[84:87], a[60:63], v[152:159], v11 abid:1
    s_waitcnt vmcnt(12)
    v_mov_b32 v39, 0
    v_smfmac_f32_16x16x64_bf16 v[72:75], a[64:67], v[160:167], v11
    v_smfmac_f32_16x16x64_bf16 v[76:79], a[64:67], v[160:167], v11 abid:1
    buffer_load_dwordx4 a[108:111], v130, s[44:47], s60 offen offset:1024 sc1
    s_waitcnt lgkmcnt(0)
    v_smfmac_f32_16x16x64_bf16 v[80:83], a[64:67], v[168:175], v11
    v_add_f32 v24, v24, v96
    v_add_f32 v25, v25, v97
    v_smfmac_f32_16x16x64_bf16 v[84:87], a[64:67], v[168:175], v11 abid:1
    s_waitcnt vmcnt(12)
    v_add_f32 v28, v28, v98
    v_smfmac_f32_16x16x64_bf16 v[72:75], a[68:71], v[176:183], v11
    v_add_f32 v29, v29, v99
    v_smfmac_f32_16x16x64_bf16 v[76:79], a[68:71], v[176:183], v11 abid:1
    buffer_load_dwordx4 a[112:115], v130, s[44:47], s60 offen offset:2048 sc1
    v_add_f32 v24, v24, v100
    v_smfmac_f32_16x16x64_bf16 v[80:83], a[68:71], v[184:191], v11
    v_add_f32 v25, v25, v101
    v_smfmac_f32_16x16x64_bf16 v[84:87], a[68:71], v[184:191], v11 abid:1
    s_waitcnt vmcnt(12)
    v_add_f32 v28, v28, v102
    v_smfmac_f32_16x16x64_bf16 v[72:75], a[72:75], v[192:199], v11
    v_add_f32 v29, v29, v103
    v_add_f32 v24, v24, v104
    v_smfmac_f32_16x16x64_bf16 v[76:79], a[72:75], v[192:199], v11 abid:1
    buffer_load_dwordx4 a[116:119], v130, s[44:47], s60 offen offset:3072 sc1
    v_add_f32 v25, v25, v105
    v_smfmac_f32_16x16x64_bf16 v[80:83], a[72:75], v[200:207], v11
    v_add_f32 v28, v28, v106
    v_smfmac_f32_16x16x64_bf16 v[84:87], a[72:75], v[200:207], v11 abid:1
    s_waitcnt vmcnt(11)
    v_add_f32 v29, v29, v107
    v_smfmac_f32_16x16x64_bf16 v[72:75], a[76:79], v[208:215], v11
    v_cvt_pk_bf16_f32 v140, v24, v28
    v_smfmac_f32_16x16x64_bf16 v[76:79], a[76:79], v[208:215], v11 abid:1
    s_mov_b32 s60, 98304
    buffer_load_dwordx4 a[120:123], v130, s[44:47], s60 offen offset:0 sc1
    v_cvt_pk_bf16_f32 v141, v25, v29
    v_smfmac_f32_16x16x64_bf16 v[80:83], a[76:79], v[216:223], v11
    global_store_dword v136, v140, s[76:77] offset:0 sc1
    v_lshlrev_b32 v24, 16, v138
    v_smfmac_f32_16x16x64_bf16 v[84:87], a[76:79], v[216:223], v11 abid:1
    global_store_dword v136, v141, s[76:77] offset:1024 sc1
    v_and_b32 v25, 0xffff0000, v138
    s_waitcnt vmcnt(13)
    v_smfmac_f32_16x16x64_bf16 v[72:75], a[80:83], v[224:231], v11
    v_lshlrev_b32 v28, 16, v139
    v_smfmac_f32_16x16x64_bf16 v[76:79], a[80:83], v[224:231], v11 abid:1
    buffer_load_dwordx4 a[124:127], v130, s[44:47], s60 offen offset:1024 sc1
    v_and_b32 v29, 0xffff0000, v139
    v_smfmac_f32_16x16x64_bf16 v[80:83], a[80:83], v[232:239], v11
    v_smfmac_f32_16x16x64_bf16 v[84:87], a[80:83], v[232:239], v11 abid:1
    s_waitcnt vmcnt(13)
    v_mov_b32 v26, 0
    v_smfmac_f32_16x16x64_bf16 v[72:75], a[84:87], v[240:247], v11
    v_mov_b32 v27, 0
    v_smfmac_f32_16x16x64_bf16 v[76:79], a[84:87], v[240:247], v11 abid:1
    s_add_u32 s60, s60, s78
    buffer_load_dwordx4 a[128:131], v130, s[44:47], s60 offen offset:2048 sc1
    v_mov_b32 v30, 0
    v_smfmac_f32_16x16x64_bf16 v[80:83], a[84:87], v[248:255], v11
    v_mov_b32 v31, 0
    v_smfmac_f32_16x16x64_bf16 v[84:87], a[84:87], v[248:255], v11 abid:1
    s_waitcnt vmcnt(12)
    v_smfmac_f32_16x16x64_bf16 v[24:27], a[88:91], a[192:199], v11
    v_smfmac_f32_16x16x64_bf16 v[28:31], a[88:91], a[192:199], v11 abid:1
    s_mov_b32 s60, 135168
    buffer_load_dwordx4 a[132:135], v130, s[44:47], s60 offen offset:0 sc1
    v_smfmac_f32_16x16x64_bf16 v[32:35], a[88:91], a[200:207], v11
    v_cmp_u_f32 vcc, v72, v73
    v_cmp_u_f32 s[62:63], v74, v75
    v_smfmac_f32_16x16x64_bf16 v[36:39], a[88:91], a[200:207], v11 abid:1
    s_or_b64 vcc, vcc, s[62:63]
    s_cbranch_scc1 G2_R1
G2_C1:
    s_waitcnt vmcnt(12)
    v_smfmac_f32_16x16x64_bf16 v[24:27], a[92:95], a[208:215], v11
    ds_write2st64_b64 v131, v[74:75], v[78:79] offset0:24 offset1:25
    v_smfmac_f32_16x16x64_bf16 v[28:31], a[92:95], a[208:215], v11 abid:1
    buffer_load_dwordx4 a[136:139], v130, s[44:47], s60 offen offset:1024 sc1
    v_smfmac_f32_16x16x64_bf16 v[32:35], a[92:95], a[216:223], v11
    ds_write2st64_b64 v132, v[80:81], v[84:85] offset0:32 offset1:33
    v_smfmac_f32_16x16x64_bf16 v[36:39], a[92:95], a[216:223], v11 abid:1
    s_waitcnt vmcnt(12)
    v_smfmac_f32_16x16x64_bf16 v[24:27], a[96:99], a[224:231], v11
    ds_write2st64_b64 v133, v[82:83], v[86:87] offset0:40 offset1:41
    v_smfmac_f32_16x16x64_bf16 v[28:31], a[96:99], a[224:231], v11 abid:1
    buffer_load_dwordx4 a[140:143], v130, s[44:47], s60 offen offset:2048 sc1
    v_smfmac_f32_16x16x64_bf16 v[32:35], a[96:99], a[232:239], v11
    v_xor_b32 v135, 96, v137
    v_smfmac_f32_16x16x64_bf16 v[36:39], a[96:99], a[232:239], v11 abid:1
    ds_read2_b32 v[138:139], v135 offset1:32
    v_mov_b32 v80, 0
    s_waitcnt vmcnt(12)
    v_smfmac_f32_16x16x64_bf16 v[24:27], a[100:103], a[240:247], v11
    s_waitcnt lgkmcnt(1)
    s_barrier
    v_mov_b32 v81, 0
    v_smfmac_f32_16x16x64_bf16 v[28:31], a[100:103], a[240:247], v11 abid:1
    buffer_load_dwordx4 a[144:147], v130, s[44:47], s60 offen offset:3072 sc1
    ds_read2st64_b64 v[96:99], v134 offset0:24 offset1:25
    v_mov_b32 v82, 0
    v_smfmac_f32_16x16x64_bf16 v[32:35], a[100:103], a[248:255], v11
    ds_read2st64_b64 v[100:103], v134 offset0:32 offset1:33
    s_add_u32 s76, s24, 16384
    s_addc_u32 s77, s25, 0
    v_mov_b32 v83, 0
    v_smfmac_f32_16x16x64_bf16 v[36:39], a[100:103], a[248:255], v11 abid:1
    ds_read2st64_b64 v[104:107], v134 offset0:40 offset1:41
    s_waitcnt vmcnt(12)
    v_smfmac_f32_16x16x64_bf16 v[24:27], a[104:107], v[144:151], v11
    v_mov_b32 v84, 0
    v_smfmac_f32_16x16x64_bf16 v[28:31], a[104:107], v[144:151], v11 abid:1
    s_mov_b32 s60, 139264
    buffer_load_dwordx4 a[148:151], v130, s[44:47], s60 offen offset:0 sc1
    v_mov_b32 v85, 0
    v_smfmac_f32_16x16x64_bf16 v[32:35], a[104:107], v[152:159], v11
    v_mov_b32 v86, 0
    v_smfmac_f32_16x16x64_bf16 v[36:39], a[104:107], v[152:159], v11 abid:1
    s_waitcnt vmcnt(12)
    v_mov_b32 v87, 0
    v_smfmac_f32_16x16x64_bf16 v[24:27], a[108:111], v[160:167], v11
    v_smfmac_f32_16x16x64_bf16 v[28:31], a[108:111], v[160:167], v11 abid:1
    buffer_load_dwordx4 a[152:155], v130, s[44:47], s60 offen offset:1024 sc1
    s_waitcnt lgkmcnt(0)
    v_smfmac_f32_16x16x64_bf16 v[32:35], a[108:111], v[168:175], v11
    v_add_f32 v72, v72, v96
    v_add_f32 v73, v73, v97
    v_smfmac_f32_16x16x64_bf16 v[36:39], a[108:111], v[168:175], v11 abid:1
    s_waitcnt vmcnt(12)
    v_add_f32 v76, v76, v98
    v_smfmac_f32_16x16x64_bf16 v[24:27], a[112:115], v[176:183], v11
    v_add_f32 v77, v77, v99
    v_smfmac_f32_16x16x64_bf16 v[28:31], a[112:115], v[176:183], v11 abid:1
    buffer_load_dwordx4 a[156:159], v130, s[44:47], s60 offen offset:2048 sc1
    v_add_f32 v72, v72, v100
    v_smfmac_f32_16x16x64_bf16 v[32:35], a[112:115], v[184:191], v11
    v_add_f32 v73, v73, v101
    v_smfmac_f32_16x16x64_bf16 v[36:39], a[112:115], v[184:191], v11 abid:1
    s_waitcnt vmcnt(12)
    v_add_f32 v76, v76, v102
    v_smfmac_f32_16x16x64_bf16 v[24:27], a[116:119], v[192:199], v11
    v_add_f32 v77, v77, v103
    v_add_f32 v72, v72, v104
    v_smfmac_f32_16x16x64_bf16 v[28:31], a[116:119], v[192:199], v11 abid:1
    buffer_load_dwordx4 a[160:163], v130, s[44:47], s60 offen offset:3072 sc1
    v_add_f32 v73, v73, v105
    v_smfmac_f32_16x16x64_bf16 v[32:35], a[116:119], v[200:207], v11
    v_add_f32 v76, v76, v106
    v_smfmac_f32_16x16x64_bf16 v[36:39], a[116:119], v[200:207], v11 abid:1
    s_waitcnt vmcnt(12)
    v_add_f32 v77, v77, v107
    v_smfmac_f32_16x16x64_bf16 v[24:27], a[120:123], v[208:215], v11
    v_cvt_pk_bf16_f32 v140, v72, v76
    v_smfmac_f32_16x16x64_bf16 v[28:31], a[120:123], v[208:215], v11 abid:1
    s_mov_b32 s60, 143360
    buffer_load_dwordx4 a[164:167], v130, s[44:47], s60 offen offset:0 sc1
    v_cvt_pk_bf16_f32 v141, v73, v77
    v_smfmac_f32_16x16x64_bf16 v[32:35], a[120:123], v[216:223], v11
    global_store_dword v136, v140, s[76:77] offset:0 sc1
    v_lshlrev_b32 v72, 16, v138
    v_smfmac_f32_16x16x64_bf16 v[36:39], a[120:123], v[216:223], v11 abid:1
    global_store_dword v136, v141, s[76:77] offset:1024 sc1
    v_and_b32 v73, 0xffff0000, v138
    s_waitcnt vmcnt(12)
    v_smfmac_f32_16x16x64_bf16 v[24:27], a[124:127], v[224:231], v11
    v_lshlrev_b32 v76, 16, v139
    v_smfmac_f32_16x16x64_bf16 v[28:31], a[124:127], v[224:231], v11 abid:1
    buffer_load_dwordx4 a[168:171], v130, s[44:47], s60 offen offset:1024 sc1
    v_and_b32 v77, 0xffff0000, v139
    v_smfmac_f32_16x16x64_bf16 v[32:35], a[124:127], v[232:239], v11
    v_smfmac_f32_16x16x64_bf16 v[36:39], a[124:127], v[232:239], v11 abid:1
    s_waitcnt vmcnt(12)
    v_mov_b32 v74, 0
    v_smfmac_f32_16x16x64_bf16 v[24:27], a[128:131], v[240:247], v11
    v_mov_b32 v75, 0
    v_smfmac_f32_16x16x64_bf16 v[28:31], a[128:131], v[240:247], v11 abid:1
    s_add_u32 s60, s60, s78
    buffer_load_dwordx4 a[172:175], v130, s[44:47], s60 offen offset:2048 sc1
    v_mov_b32 v78, 0
    v_smfmac_f32_16x16x64_bf16 v[32:35], a[128:131], v[248:255], v11
    v_mov_b32 v79, 0
    v_smfmac_f32_16x16x64_bf16 v[36:39], a[128:131], v[248:255], v11 abid:1
    s_waitcnt vmcnt(12)
    v_smfmac_f32_16x16x64_bf16 v[72:75], a[132:135], a[192:199], v11
    v_smfmac_f32_16x16x64_bf16 v[76:79], a[132:135], a[192:199], v11 abid:1
    v_smfmac_f32_16x16x64_bf16 v[80:83], a[132:135], a[200:207], v11
    v_cmp_u_f32 vcc, v24, v25
    v_cmp_u_f32 s[62:63], v26, v27
    v_smfmac_f32_16x16x64_bf16 v[84:87], a[132:135], a[200:207], v11 abid:1
    s_or_b64 vcc, vcc, s[62:63]
    s_cbranch_scc1 G2_R2
G2_C2:
    s_waitcnt vmcnt(11)
    v_smfmac_f32_16x16x64_bf16 v[72:75], a[136:139], a[208:215], v11
    ds_write2st64_b64 v131, v[26:27], v[30:31] offset0:0 offset1:1
    v_smfmac_f32_16x16x64_bf16 v[76:79], a[136:139], a[208:215], v11 abid:1
    v_smfmac_f32_16x16x64_bf16 v[80:83], a[136:139], a[216:223], v11
    ds_write2st64_b64 v132, v[32:33], v[36:37] offset0:8 offset1:9
    v_smfmac_f32_16x16x64_bf16 v[84:87], a[136:139], a[216:223], v11 abid:1
    s_waitcnt vmcnt(10)
    v_smfmac_f32_16x16x64_bf16 v[72:75], a[140:143], a[224:231], v11
    ds_write2st64_b64 v133, v[34:35], v[38:39] offset0:16 offset1:17
    v_smfmac_f32_16x16x64_bf16 v[76:79], a[140:143], a[224:231], v11 abid:1
    v_smfmac_f32_16x16x64_bf16 v[80:83], a[140:143], a[232:239], v11
    v_smfmac_f32_16x16x64_bf16 v[84:87], a[140:143], a[232:239], v11 abid:1
    s_waitcnt vmcnt(9)
    v_smfmac_f32_16x16x64_bf16 v[72:75], a[144:147], a[240:247], v11
    s_waitcnt lgkmcnt(0)
    s_barrier
    v_smfmac_f32_16x16x64_bf16 v[76:79], a[144:147], a[240:247], v11 abid:1
    ds_read2st64_b64 v[96:99], v134 offset0:0 offset1:1
    v_smfmac_f32_16x16x64_bf16 v[80:83], a[144:147], a[248:255], v11
    ds_read2st64_b64 v[100:103], v134 offset0:8 offset1:9
    s_add_u32 s76, s24, 32768
    s_addc_u32 s77, s25, 0
    v_smfmac_f32_16x16x64_bf16 v[84:87], a[144:147], a[248:255], v11 abid:1
    ds_read2st64_b64 v[104:107], v134 offset0:16 offset1:17
    s_waitcnt vmcnt(8)
    v_smfmac_f32_16x16x64_bf16 v[72:75], a[148:151], v[144:151], v11
    v_smfmac_f32_16x16x64_bf16 v[76:79], a[148:151], v[144:151], v11 abid:1
    v_smfmac_f32_16x16x64_bf16 v[80:83], a[148:151], v[152:159], v11
    v_smfmac_f32_16x16x64_bf16 v[84:87], a[148:151], v[152:159], v11 abid:1
    s_waitcnt vmcnt(7)
    v_smfmac_f32_16x16x64_bf16 v[72:75], a[152:155], v[160:167], v11
    v_smfmac_f32_16x16x64_bf16 v[76:79], a[152:155], v[160:167], v11 abid:1
    s_waitcnt lgkmcnt(0)
    v_smfmac_f32_16x16x64_bf16 v[80:83], a[152:155], v[168:175], v11
    v_add_f32 v24, v24, v96
    v_add_f32 v25, v25, v97
    v_smfmac_f32_16x16x64_bf16 v[84:87], a[152:155], v[168:175], v11 abid:1
    s_waitcnt vmcnt(6)
    v_add_f32 v28, v28, v98
    v_smfmac_f32_16x16x64_bf16 v[72:75], a[156:159], v[176:183], v11
    v_add_f32 v29, v29, v99
    v_smfmac_f32_16x16x64_bf16 v[76:79], a[156:159], v[176:183], v11 abid:1
    v_add_f32 v24, v24, v100
    v_smfmac_f32_16x16x64_bf16 v[80:83], a[156:159], v[184:191], v11
    v_add_f32 v25, v25, v101
    v_smfmac_f32_16x16x64_bf16 v[84:87], a[156:159], v[184:191], v11 abid:1
    s_waitcnt vmcnt(5)
    v_add_f32 v28, v28, v102
    v_smfmac_f32_16x16x64_bf16 v[80:83], a[160:163], v[200:207], v11
    v_add_f32 v29, v29, v103
    v_add_f32 v24, v24, v104
    v_smfmac_f32_16x16x64_bf16 v[84:87], a[160:163], v[200:207], v11 abid:1
    s_waitcnt vmcnt(4)
    v_add_f32 v25, v25, v105
    v_smfmac_f32_16x16x64_bf16 v[80:83], a[164:167], v[216:223], v11
    v_add_f32 v28, v28, v106
    v_smfmac_f32_16x16x64_bf16 v[84:87], a[164:167], v[216:223], v11 abid:1
    s_waitcnt vmcnt(1)
    v_add_f32 v29, v29, v107
    v_smfmac_f32_16x16x64_bf16 v[80:83], a[168:171], v[232:239], v11
    v_cvt_pk_bf16_f32 v140, v24, v28
    v_smfmac_f32_16x16x64_bf16 v[84:87], a[168:171], v[232:239], v11 abid:1
    s_waitcnt vmcnt(0)
    v_cvt_pk_bf16_f32 v141, v25, v29
    v_smfmac_f32_16x16x64_bf16 v[80:83], a[172:175], v[248:255], v11
    global_store_dword v136, v140, s[76:77] offset:0 sc1
    v_smfmac_f32_16x16x64_bf16 v[84:87], a[172:175], v[248:255], v11 abid:1
    global_store_dword v136, v141, s[76:77] offset:1024 sc1
    v_smfmac_f32_16x16x64_bf16 v[72:75], a[160:163], v[192:199], v11
    v_smfmac_f32_16x16x64_bf16 v[76:79], a[160:163], v[192:199], v11 abid:1
    v_smfmac_f32_16x16x64_bf16 v[72:75], a[164:167], v[208:215], v11
    s_nop 1
    v_cmp_u_f32 vcc, v80, v81
    v_cmp_u_f32 s[62:63], v82, v83
    v_smfmac_f32_16x16x64_bf16 v[76:79], a[164:167], v[208:215], v11 abid:1
    s_or_b64 vcc, vcc, s[62:63]
    s_cbranch_scc1 G2_R3
G2_C3:
    v_smfmac_f32_16x16x64_bf16 v[72:75], a[168:171], v[224:231], v11
    ds_write2st64_b64 v132, v[80:81], v[84:85] offset0:32 offset1:33
    v_smfmac_f32_16x16x64_bf16 v[76:79], a[168:171], v[224:231], v11 abid:1
    s_add_u32 s76, s24, 49152
    s_addc_u32 s77, s25, 0
    v_smfmac_f32_16x16x64_bf16 v[72:75], a[172:175], v[240:247], v11
    ds_write2st64_b64 v133, v[82:83], v[86:87] offset0:40 offset1:41
    v_smfmac_f32_16x16x64_bf16 v[76:79], a[172:175], v[240:247], v11 abid:1
    s_nop 7
    ds_write2st64_b64 v131, v[74:75], v[78:79] offset0:24 offset1:25
    s_waitcnt lgkmcnt(0)
    s_barrier
    ds_read2st64_b64 v[96:99], v134 offset0:24 offset1:25
    ds_read2st64_b64 v[100:103], v134 offset0:32 offset1:33
    ds_read2st64_b64 v[104:107], v134 offset0:40 offset1:41
    s_waitcnt lgkmcnt(2)
    v_pk_add_f32 v[72:73], v[72:73], v[96:97]
    v_pk_add_f32 v[76:77], v[76:77], v[98:99]
    s_waitcnt lgkmcnt(1)
    v_pk_add_f32 v[72:73], v[72:73], v[100:101]
    v_pk_add_f32 v[76:77], v[76:77], v[102:103]
    s_waitcnt lgkmcnt(0)
    v_pk_add_f32 v[72:73], v[72:73], v[104:105]
    v_pk_add_f32 v[76:77], v[76:77], v[106:107]
    v_cvt_pk_bf16_f32 v140, v72, v76
    v_cvt_pk_bf16_f32 v141, v73, v77
    global_store_dword v136, v140, s[76:77] offset:0
    global_store_dword v136, v141, s[76:77] offset:1024
K_END:
    s_endpgm
S1_RETRY:
    s_add_u32 s69, s69, 1
    s_cmp_gt_u32 s69, 20000
    s_cbranch_scc1 S1_OK
    global_load_dwordx4 v[220:223], v255, s[28:29] offset:0 sc1
    global_load_dwordx4 v[224:227], v255, s[28:29] offset:128 sc1
    global_load_dwordx4 v[228:231], v255, s[28:29] offset:256 sc1
    global_load_dwordx4 v[232:235], v254, s[28:29] offset:0 sc1
    global_load_dwordx4 v[236:239], v254, s[28:29] offset:1024 sc1
    global_load_dwordx4 v[240:243], v254, s[28:29] offset:2048 sc1
    global_load_dwordx4 v[244:247], v254, s[28:29] offset:3072 sc1
    global_load_dword v98, v99, s[28:29] sc1
    s_waitcnt vmcnt(0)
    s_branch S1_CHK
CLR_X:
    s_mov_b32 s60, 0
    buffer_store_dwordx4 v[108:111], v128, s[44:47], s60 offen sc1
    s_mov_b32 s60, 45056
    buffer_store_dwordx4 v[108:111], v128, s[44:47], s60 offen sc1
    s_mov_b32 s60, 90112
    buffer_store_dwordx4 v[108:111], v128, s[44:47], s60 offen sc1
    s_mov_b32 s60, 135168
    buffer_store_dwordx4 v[108:111], v128, s[44:47], s60 offen sc1
    s_mov_b32 s60, 0
    buffer_store_dwordx4 v[108:111], v218, s[44:47], s60 offen sc1
    s_mov_b32 s60, 45056
    buffer_store_dwordx4 v[108:111], v218, s[44:47], s60 offen sc1
    s_branch CLR_D
EP_BUMP:
    v_mov_b32 v72, 0
    v_mov_b32 v73, s55
    s_mov_b64 exec, 1
    global_store_dword v72, v73, s[28:29] sc1
    s_mov_b64 exec, -1
    s_branch EP_DONE
CK_R0:
    s_add_u32 s79, s79, 1
    s_cmp_gt_u32 s79, 20000
    s_cbranch_scc1 CK_D0
    s_waitcnt lgkmcnt(0)
    s_barrier
    s_lshl_b32 s61, s3, 10
    s_add_u32 m0, s61, 0
    s_mov_b32 s60, 0
    buffer_load_dwordx4 v119, s[40:43], s60 offen sc1 lds
    s_add_u32 m0, s61, 4096
    s_mov_b32 s60, 131072
    buffer_load_dwordx4 v119, s[40:43], s60 offen sc1 lds
    s_add_u32 m0, s61, 8192
    s_mov_b32 s60, 262144
    buffer_load_dwordx4 v119, s[40:43], s60 offen sc1 lds
    s_add_u32 m0, s61, 12288
    s_mov_b32 s60, 393216
    buffer_load_dwordx4 v119, s[40:43], s60 offen sc1 lds
    s_waitcnt vmcnt(0)
    s_branch CK_C0
CK_R1:
    s_add_u32 s69, s69, 1
    s_cmp_gt_u32 s69, 20000
    s_cbranch_scc1 CK_C1
    s_lshl_b32 s61, s3, 10
    s_add_u32 m0, s61, 16384
    s_mov_b32 s60, 524288
    buffer_load_dwordx4 v119, s[40:43], s60 offen sc1 lds
    s_add_u32 m0, s61, 20480
    s_mov_b32 s60, 655360
    buffer_load_dwordx4 v119, s[40:43], s60 offen sc1 lds
    s_add_u32 m0, s61, 24576
    s_mov_b32 s60, 786432
    buffer_load_dwordx4 v119, s[40:43], s60 offen sc1 lds
    s_add_u32 m0, s61, 28672
    s_mov_b32 s60, 917504
    buffer_load_dwordx4 v119, s[40:43], s60 offen sc1 lds
    s_waitcnt vmcnt(0)
    ds_read_b32 v121, v120 offset:16384
    s_waitcnt lgkmcnt(0)
    v_cmp_eq_u32 vcc, -1, v121
    s_cbranch_vccnz CK_R1
    s_branch CK_C1
CK_R2:
    s_add_u32 s69, s69, 1
    s_cmp_gt_u32 s69, 20000
    s_cbranch_scc1 CK_C2
    s_lshl_b32 s61, s3, 10
    s_add_u32 m0, s61, 32768
    s_mov_b32 s60, 1048576
    buffer_load_dwordx4 v119, s[40:43], s60 offen sc1 lds
    s_add_u32 m0, s61, 36864
    s_mov_b32 s60, 1179648
    buffer_load_dwordx4 v119, s[40:43], s60 offen sc1 lds
    s_add_u32 m0, s61, 40960
    s_mov_b32 s60, 1310720
    buffer_load_dwordx4 v119, s[40:43], s60 offen sc1 lds
    s_add_u32 m0, s61, 45056
    s_mov_b32 s60, 1441792
    buffer_load_dwordx4 v119, s[40:43], s60 offen sc1 lds
    s_waitcnt vmcnt(0)
    ds_read_b32 v121, v120 offset:32768
    s_waitcnt lgkmcnt(0)
    v_cmp_eq_u32 vcc, -1, v121
    s_cbranch_vccnz CK_R2
    s_branch CK_C2
CK_R3:
    s_add_u32 s69, s69, 1
    s_cmp_gt_u32 s69, 20000
    s_cbranch_scc1 CK_C3
    s_lshl_b32 s61, s3, 10
    s_add_u32 m0, s61, 49152
    s_mov_b32 s60, 1572864
    buffer_load_dwordx4 v119, s[40:43], s60 offen sc1 lds
    s_add_u32 m0, s61, 53248
    s_mov_b32 s60, 1703936
    buffer_load_dwordx4 v119, s[40:43], s60 offen sc1 lds
    s_add_u32 m0, s61, 57344
    s_mov_b32 s60, 1835008
    buffer_load_dwordx4 v119, s[40:43], s60 offen sc1 lds
    s_add_u32 m0, s61, 61440
    s_mov_b32 s60, 1966080
    buffer_load_dwordx4 v119, s[40:43], s60 offen sc1 lds
    s_waitcnt vmcnt(0)
    ds_read_b32 v121, v120 offset:49152
    s_waitcnt lgkmcnt(0)
    v_cmp_eq_u32 vcc, -1, v121
    s_cbranch_vccnz CK_R3
    s_branch CK_C3
S2_REDO:
    s_add_u32 s79, s79, 1
    s_cmp_gt_u32 s79, 20000
    s_cbranch_scc1 S2_GO
    s_nop 7
    s_nop 7
    v_mov_b32 v24, 0
    v_mov_b32 v25, 0
    v_mov_b32 v26, 0
    v_mov_b32 v27, 0
    v_mov_b32 v28, 0
    v_mov_b32 v29, 0
    v_mov_b32 v30, 0
    v_mov_b32 v31, 0
    v_mov_b32 v32, 0
    v_mov_b32 v33, 0
    v_mov_b32 v34, 0
    v_mov_b32 v35, 0
    v_mov_b32 v36, 0
    v_mov_b32 v37, 0
    v_mov_b32 v38, 0
    v_mov_b32 v39, 0
    v_mov_b32 v40, 0
    v_mov_b32 v41, 0
    v_mov_b32 v42, 0
    v_mov_b32 v43, 0
    v_mov_b32 v44, 0
    v_mov_b32 v45, 0
    v_mov_b32 v46, 0
    v_mov_b32 v47, 0
    v_mov_b32 v48, 0
    v_mov_b32 v49, 0
    v_mov_b32 v50, 0
    v_mov_b32 v51, 0
    v_mov_b32 v52, 0
    v_mov_b32 v53, 0
    v_mov_b32 v54, 0
    v_mov_b32 v55, 0
    v_mov_b32 v64, 0
    v_mov_b32 v65, 0
    v_mov_b32 v66, 0
    v_mov_b32 v67, 0
    v_mov_b32 v68, 0
    v_mov_b32 v69, 0
    v_mov_b32 v70, 0
    v_mov_b32 v71, 0
    s_waitcnt vmcnt(0) lgkmcnt(0)
    s_branch S2_TRY
FL_R0:
    s_add_u32 s79, s79, 1
    s_cmp_gt_u32 s79, 1280000
    s_cbranch_scc1 FL_C0
    ds_read_b32 v121, v1 offset:0
    ds_read_b128 v[108:111], v19 offset:0
    s_waitcnt lgkmcnt(0)
    v_cmp_eq_u32 vcc, 0, v121
    s_cbranch_vccnz FL_R0
    s_branch FL_C0
FL_R1:
    s_add_u32 s79, s79, 1
    s_cmp_gt_u32 s79, 1280000
    s_cbranch_scc1 FL_C1
    ds_read_b32 v121, v1 offset:1024
    ds_read_b128 v[108:111], v19 offset:4096
    s_waitcnt lgkmcnt(0)
    v_cmp_eq_u32 vcc, 0, v121
    s_cbranch_vccnz FL_R1
    s_branch FL_C1
FL_R2:
    s_add_u32 s79, s79, 1
    s_cmp_gt_u32 s79, 1280000
    s_cbranch_scc1 FL_C2
    ds_read_b32 v121, v1 offset:2048
    ds_read_b128 v[108:111], v19 offset:0
    s_waitcnt lgkmcnt(0)
    v_cmp_eq_u32 vcc, 0, v121
    s_cbranch_vccnz FL_R2
    s_branch FL_C2
FL_R3:
    s_add_u32 s79, s79, 1
    s_cmp_gt_u32 s79, 1280000
    s_cbranch_scc1 FL_C3
    ds_read_b32 v121, v1 offset:3072
    ds_read_b128 v[108:111], v19 offset:4096
    s_waitcnt lgkmcnt(0)
    v_cmp_eq_u32 vcc, 0, v121
    s_cbranch_vccnz FL_R3
    s_branch FL_C3
G2_R0:
    s_add_u32 s69, s69, 1
    s_cmp_gt_u32 s69, 20000
    s_cbranch_scc1 G2_C0
    s_mov_b32 s61, s60
    s_mov_b32 s60, 0
    buffer_load_dwordx4 a[0:3], v130, s[44:47], s60 offen offset:0 sc1
    buffer_load_dwordx4 a[4:7], v130, s[44:47], s60 offen offset:1024 sc1
    buffer_load_dwordx4 a[8:11], v130, s[44:47], s60 offen offset:2048 sc1
    buffer_load_dwordx4 a[12:15], v130, s[44:47], s60 offen offset:3072 sc1
    s_mov_b32 s60, 4096
    buffer_load_dwordx4 a[16:19], v130, s[44:47], s60 offen offset:0 sc1
    buffer_load_dwordx4 a[20:23], v130, s[44:47], s60 offen offset:1024 sc1
    buffer_load_dwordx4 a[24:27], v130, s[44:47], s60 offen offset:2048 sc1
    buffer_load_dwordx4 a[28:31], v130, s[44:47], s60 offen offset:3072 sc1
    s_mov_b32 s60, 8192
    buffer_load_dwordx4 a[32:35], v130, s[44:47], s60 offen offset:0 sc1
    buffer_load_dwordx4 a[36:39], v130, s[44:47], s60 offen offset:1024 sc1
    s_add_u32 s60, s60, s78
    buffer_load_dwordx4 a[40:43], v130, s[44:47], s60 offen offset:2048 sc1
    s_mov_b32 s60, s61
    v_xor_b32 v140, 0, v137
    ds_read2_b32 v[96:97], v140 offset1:32
    s_waitcnt vmcnt(0) lgkmcnt(0)
    v_lshlrev_b32 v24, 16, v96
    v_and_b32 v25, 0xffff0000, v96
    v_lshlrev_b32 v28, 16, v97
    v_and_b32 v29, 0xffff0000, v97
    v_mov_b32 v26, 0
    v_mov_b32 v27, 0
    v_mov_b32 v30, 0
    v_mov_b32 v31, 0
    v_mov_b32 v32, 0
    v_mov_b32 v33, 0
    v_mov_b32 v34, 0
    v_mov_b32 v35, 0
    v_mov_b32 v36, 0
    v_mov_b32 v37, 0
    v_mov_b32 v38, 0
    v_mov_b32 v39, 0
    v_smfmac_f32_16x16x64_bf16 v[24:27], a[0:3], a[192:199], v11
    v_smfmac_f32_16x16x64_bf16 v[28:31], a[0:3], a[192:199], v11 abid:1
    v_smfmac_f32_16x16x64_bf16 v[32:35], a[0:3], a[200:207], v11
    v_smfmac_f32_16x16x64_bf16 v[36:39], a[0:3], a[200:207], v11 abid:1
    v_smfmac_f32_16x16x64_bf16 v[24:27], a[4:7], a[208:215], v11
    v_smfmac_f32_16x16x64_bf16 v[28:31], a[4:7], a[208:215], v11 abid:1
    v_smfmac_f32_16x16x64_bf16 v[32:35], a[4:7], a[216:223], v11
    v_smfmac_f32_16x16x64_bf16 v[36:39], a[4:7], a[216:223], v11 abid:1
    v_smfmac_f32_16x16x64_bf16 v[24:27], a[8:11], a[224:231], v11
    v_smfmac_f32_16x16x64_bf16 v[28:31], a[8:11], a[224:231], v11 abid:1
    v_smfmac_f32_16x16x64_bf16 v[32:35], a[8:11], a[232:239], v11
    v_smfmac_f32_16x16x64_bf16 v[36:39], a[8:11], a[232:239], v11 abid:1
    v_smfmac_f32_16x16x64_bf16 v[24:27], a[12:15], a[240:247], v11
    v_smfmac_f32_16x16x64_bf16 v[28:31], a[12:15], a[240:247], v11 abid:1
    v_smfmac_f32_16x16x64_bf16 v[32:35], a[12:15], a[248:255], v11
    v_smfmac_f32_16x16x64_bf16 v[36:39], a[12:15], a[248:255], v11 abid:1
    v_smfmac_f32_16x16x64_bf16 v[24:27], a[16:19], v[144:151], v11
    v_smfmac_f32_16x16x64_bf16 v[28:31], a[16:19], v[144:151], v11 abid:1
    v_smfmac_f32_16x16x64_bf16 v[32:35], a[16:19], v[152:159], v11
    v_smfmac_f32_16x16x64_bf16 v[36:39], a[16:19], v[152:159], v11 abid:1
    v_smfmac_f32_16x16x64_bf16 v[24:27], a[20:23], v[160:167], v11
    v_smfmac_f32_16x16x64_bf16 v[28:31], a[20:23], v[160:167], v11 abid:1
    v_smfmac_f32_16x16x64_bf16 v[32:35], a[20:23], v[168:175], v11
    v_smfmac_f32_16x16x64_bf16 v[36:39], a[20:23], v[168:175], v11 abid:1
    v_smfmac_f32_16x16x64_bf16 v[24:27], a[24:27], v[176:183], v11
    v_smfmac_f32_16x16x64_bf16 v[28:31], a[24:27], v[176:183], v11 abid:1
    v_smfmac_f32_16x16x64_bf16 v[32:35], a[24:27], v[184:191], v11
    v_smfmac_f32_16x16x64_bf16 v[36:39], a[24:27], v[184:191], v11 abid:1
    v_smfmac_f32_16x16x64_bf16 v[24:27], a[28:31], v[192:199], v11
    v_smfmac_f32_16x16x64_bf16 v[28:31], a[28:31], v[192:199], v11 abid:1
    v_smfmac_f32_16x16x64_bf16 v[32:35], a[28:31], v[200:207], v11
    v_smfmac_f32_16x16x64_bf16 v[36:39], a[28:31], v[200:207], v11 abid:1
    v_smfmac_f32_16x16x64_bf16 v[24:27], a[32:35], v[208:215], v11
    v_smfmac_f32_16x16x64_bf16 v[28:31], a[32:35], v[208:215], v11 abid:1
    v_smfmac_f32_16x16x64_bf16 v[32:35], a[32:35], v[216:223], v11
    v_smfmac_f32_16x16x64_bf16 v[36:39], a[32:35], v[216:223], v11 abid:1
    v_smfmac_f32_16x16x64_bf16 v[24:27], a[36:39], v[224:231], v11
    v_smfmac_f32_16x16x64_bf16 v[28:31], a[36:39], v[224:231], v11 abid:1
    v_smfmac_f32_16x16x64_bf16 v[32:35], a[36:39], v[232:239], v11
    v_smfmac_f32_16x16x64_bf16 v[36:39], a[36:39], v[232:239], v11 abid:1
    v_smfmac_f32_16x16x64_bf16 v[24:27], a[40:43], v[240:247], v11
    v_smfmac_f32_16x16x64_bf16 v[28:31], a[40:43], v[240:247], v11 abid:1
    v_smfmac_f32_16x16x64_bf16 v[32:35], a[40:43], v[248:255], v11
    v_smfmac_f32_16x16x64_bf16 v[36:39], a[40:43], v[248:255], v11 abid:1
    s_nop 7
    v_cmp_u_f32 vcc, v24, v25
    s_cbranch_vccnz G2_R0
    v_cmp_u_f32 vcc, v26, v27
    s_cbranch_vccnz G2_R0
    s_branch G2_C0
G2_R1:
    s_add_u32 s69, s69, 1
    s_cmp_gt_u32 s69, 20000
    s_cbranch_scc1 G2_C1
    s_mov_b32 s61, s60
    s_mov_b32 s60, 45056
    buffer_load_dwordx4 a[44:47], v130, s[44:47], s60 offen offset:0 sc1
    buffer_load_dwordx4 a[48:51], v130, s[44:47], s60 offen offset:1024 sc1
    buffer_load_dwordx4 a[52:55], v130, s[44:47], s60 offen offset:2048 sc1
    buffer_load_dwordx4 a[56:59], v130, s[44:47], s60 offen offset:3072 sc1
    s_mov_b32 s60, 49152
    buffer_load_dwordx4 a[60:63], v130, s[44:47], s60 offen offset:0 sc1
    buffer_load_dwordx4 a[64:67], v130, s[44:47], s60 offen offset:1024 sc1
    buffer_load_dwordx4 a[68:71], v130, s[44:47], s60 offen offset:2048 sc1
    buffer_load_dwordx4 a[72:75], v130, s[44:47], s60 offen offset:3072 sc1
    s_mov_b32 s60, 53248
    buffer_load_dwordx4 a[76:79], v130, s[44:47], s60 offen offset:0 sc1
    buffer_load_dwordx4 a[80:83], v130, s[44:47], s60 offen offset:1024 sc1
    s_add_u32 s60, s60, s78
    buffer_load_dwordx4 a[84:87], v130, s[44:47], s60 offen offset:2048 sc1
    s_mov_b32 s60, s61
    v_xor_b32 v140, 32, v137
    ds_read2_b32 v[96:97], v140 offset1:32
    s_waitcnt vmcnt(0) lgkmcnt(0)
    v_lshlrev_b32 v72, 16, v96
    v_and_b32 v73, 0xffff0000, v96
    v_lshlrev_b32 v76, 16, v97
    v_and_b32 v77, 0xffff0000, v97
    v_mov_b32 v74, 0
    v_mov_b32 v75, 0
    v_mov_b32 v78, 0
    v_mov_b32 v79, 0
    v_mov_b32 v80, 0
    v_mov_b32 v81, 0
    v_mov_b32 v82, 0
    v_mov_b32 v83, 0
    v_mov_b32 v84, 0
    v_mov_b32 v85, 0
    v_mov_b32 v86, 0
    v_mov_b32 v87, 0
    v_smfmac_f32_16x16x64_bf16 v[72:75], a[44:47], a[192:199], v11
    v_smfmac_f32_16x16x64_bf16 v[76:79], a[44:47], a[192:199], v11 abid:1
    v_smfmac_f32_16x16x64_bf16 v[80:83], a[44:47], a[200:207], v11
    v_smfmac_f32_16x16x64_bf16 v[84:87], a[44:47], a[200:207], v11 abid:1
    v_smfmac_f32_16x16x64_bf16 v[72:75], a[48:51], a[208:215], v11
    v_smfmac_f32_16x16x64_bf16 v[76:79], a[48:51], a[208:215], v11 abid:1
    v_smfmac_f32_16x16x64_bf16 v[80:83], a[48:51], a[216:223], v11
    v_smfmac_f32_16x16x64_bf16 v[84:87], a[48:51], a[216:223], v11 abid:1
    v_smfmac_f32_16x16x64_bf16 v[72:75], a[52:55], a[224:231], v11
    v_smfmac_f32_16x16x64_bf16 v[76:79], a[52:55], a[224:231], v11 abid:1
    v_smfmac_f32_16x16x64_bf16 v[80:83], a[52:55], a[232:239], v11
    v_smfmac_f32_16x16x64_bf16 v[84:87], a[52:55], a[232:239], v11 abid:1
    v_smfmac_f32_16x16x64_bf16 v[72:75], a[56:59], a[240:247], v11
    v_smfmac_f32_16x16x64_bf16 v[76:79], a[56:59], a[240:247], v11 abid:1
    v_smfmac_f32_16x16x64_bf16 v[80:83], a[56:59], a[248:255], v11
    v_smfmac_f32_16x16x64_bf16 v[84:87], a[56:59], a[248:255], v11 abid:1
    v_smfmac_f32_16x16x64_bf16 v[72:75], a[60:63], v[144:151], v11
    v_smfmac_f32_16x16x64_bf16 v[76:79], a[60:63], v[144:151], v11 abid:1
    v_smfmac_f32_16x16x64_bf16 v[80:83], a[60:63], v[152:159], v11
    v_smfmac_f32_16x16x64_bf16 v[84:87], a[60:63], v[152:159], v11 abid:1
    v_smfmac_f32_16x16x64_bf16 v[72:75], a[64:67], v[160:167], v11
    v_smfmac_f32_16x16x64_bf16 v[76:79], a[64:67], v[160:167], v11 abid:1
    v_smfmac_f32_16x16x64_bf16 v[80:83], a[64:67], v[168:175], v11
    v_smfmac_f32_16x16x64_bf16 v[84:87], a[64:67], v[168:175], v11 abid:1
    v_smfmac_f32_16x16x64_bf16 v[72:75], a[68:71], v[176:183], v11
    v_smfmac_f32_16x16x64_bf16 v[76:79], a[68:71], v[176:183], v11 abid:1
    v_smfmac_f32_16x16x64_bf16 v[80:83], a[68:71], v[184:191], v11
    v_smfmac_f32_16x16x64_bf16 v[84:87], a[68:71], v[184:191], v11 abid:1
    v_smfmac_f32_16x16x64_bf16 v[72:75], a[72:75], v[192:199], v11
    v_smfmac_f32_16x16x64_bf16 v[76:79], a[72:75], v[192:199], v11 abid:1
    v_smfmac_f32_16x16x64_bf16 v[80:83], a[72:75], v[200:207], v11
    v_smfmac_f32_16x16x64_bf16 v[84:87], a[72:75], v[200:207], v11 abid:1
    v_smfmac_f32_16x16x64_bf16 v[72:75], a[76:79], v[208:215], v11
    v_smfmac_f32_16x16x64_bf16 v[76:79], a[76:79], v[208:215], v11 abid:1
    v_smfmac_f32_16x16x64_bf16 v[80:83], a[76:79], v[216:223], v11
    v_smfmac_f32_16x16x64_bf16 v[84:87], a[76:79], v[216:223], v11 abid:1
    v_smfmac_f32_16x16x64_bf16 v[72:75], a[80:83], v[224:231], v11
    v_smfmac_f32_16x16x64_bf16 v[76:79], a[80:83], v[224:231], v11 abid:1
    v_smfmac_f32_16x16x64_bf16 v[80:83], a[80:83], v[232:239], v11
    v_smfmac_f32_16x16x64_bf16 v[84:87], a[80:83], v[232:239], v11 abid:1
    v_smfmac_f32_16x16x64_bf16 v[72:75], a[84:87], v[240:247], v11
    v_smfmac_f32_16x16x64_bf16 v[76:79], a[84:87], v[240:247], v11 abid:1
    v_smfmac_f32_16x16x64_bf16 v[80:83], a[84:87], v[248:255], v11
    v_smfmac_f32_16x16x64_bf16 v[84:87], a[84:87], v[248:255], v11 abid:1
    s_nop 7
    v_cmp_u_f32 vcc, v72, v73
    s_cbranch_vccnz G2_R1
    v_cmp_u_f32 vcc, v74, v75
    s_cbranch_vccnz G2_R1
    s_branch G2_C1
G2_R2:
    s_add_u32 s69, s69, 1
    s_cmp_gt_u32 s69, 20000
    s_cbranch_scc1 G2_C2
    s_mov_b32 s61, s60
    s_mov_b32 s60, 90112
    buffer_load_dwordx4 a[88:91], v130, s[44:47], s60 offen offset:0 sc1
    buffer_load_dwordx4 a[92:95], v130, s[44:47], s60 offen offset:1024 sc1
    buffer_load_dwordx4 a[96:99], v130, s[44:47], s60 offen offset:2048 sc1
    buffer_load_dwordx4 a[100:103], v130, s[44:47], s60 offen offset:3072 sc1
    s_mov_b32 s60, 94208
    buffer_load_dwordx4 a[104:107], v130, s[44:47], s60 offen offset:0 sc1
    buffer_load_dwordx4 a[108:111], v130, s[44:47], s60 offen offset:1024 sc1
    buffer_load_dwordx4 a[112:115], v130, s[44:47], s60 offen offset:2048 sc1
    buffer_load_dwordx4 a[116:119], v130, s[44:47], s60 offen offset:3072 sc1
    s_mov_b32 s60, 98304
    buffer_load_dwordx4 a[120:123], v130, s[44:47], s60 offen offset:0 sc1
    buffer_load_dwordx4 a[124:127], v130, s[44:47], s60 offen offset:1024 sc1
    s_add_u32 s60, s60, s78
    buffer_load_dwordx4 a[128:131], v130, s[44:47], s60 offen offset:2048 sc1
    s_mov_b32 s60, s61
    v_xor_b32 v140, 64, v137
    ds_read2_b32 v[96:97], v140 offset1:32
    s_waitcnt vmcnt(0) lgkmcnt(0)
    v_lshlrev_b32 v24, 16, v96
    v_and_b32 v25, 0xffff0000, v96
    v_lshlrev_b32 v28, 16, v97
    v_and_b32 v29, 0xffff0000, v97
    v_mov_b32 v26, 0
    v_mov_b32 v27, 0
    v_mov_b32 v30, 0
    v_mov_b32 v31, 0
    v_mov_b32 v32, 0
    v_mov_b32 v33, 0
    v_mov_b32 v34, 0
    v_mov_b32 v35, 0
    v_mov_b32 v36, 0
    v_mov_b32 v37, 0
    v_mov_b32 v38, 0
    v_mov_b32 v39, 0
    v_smfmac_f32_16x16x64_bf16 v[24:27], a[88:91], a[192:199], v11
    v_smfmac_f32_16x16x64_bf16 v[28:31], a[88:91], a[192:199], v11 abid:1
    v_smfmac_f32_16x16x64_bf16 v[32:35], a[88:91], a[200:207], v11
    v_smfmac_f32_16x16x64_bf16 v[36:39], a[88:91], a[200:207], v11 abid:1
    v_smfmac_f32_16x16x64_bf16 v[24:27], a[92:95], a[208:215], v11
    v_smfmac_f32_16x16x64_bf16 v[28:31], a[92:95], a[208:215], v11 abid:1
    v_smfmac_f32_16x16x64_bf16 v[32:35], a[92:95], a[216:223], v11
    v_smfmac_f32_16x16x64_bf16 v[36:39], a[92:95], a[216:223], v11 abid:1
    v_smfmac_f32_16x16x64_bf16 v[24:27], a[96:99], a[224:231], v11
    v_smfmac_f32_16x16x64_bf16 v[28:31], a[96:99], a[224:231], v11 abid:1
    v_smfmac_f32_16x16x64_bf16 v[32:35], a[96:99], a[232:239], v11
    v_smfmac_f32_16x16x64_bf16 v[36:39], a[96:99], a[232:239], v11 abid:1
    v_smfmac_f32_16x16x64_bf16 v[24:27], a[100:103], a[240:247], v11
    v_smfmac_f32_16x16x64_bf16 v[28:31], a[100:103], a[240:247], v11 abid:1
    v_smfmac_f32_16x16x64_bf16 v[32:35], a[100:103], a[248:255], v11
    v_smfmac_f32_16x16x64_bf16 v[36:39], a[100:103], a[248:255], v11 abid:1
    v_smfmac_f32_16x16x64_bf16 v[24:27], a[104:107], v[144:151], v11
    v_smfmac_f32_16x16x64_bf16 v[28:31], a[104:107], v[144:151], v11 abid:1
    v_smfmac_f32_16x16x64_bf16 v[32:35], a[104:107], v[152:159], v11
    v_smfmac_f32_16x16x64_bf16 v[36:39], a[104:107], v[152:159], v11 abid:1
    v_smfmac_f32_16x16x64_bf16 v[24:27], a[108:111], v[160:167], v11
    v_smfmac_f32_16x16x64_bf16 v[28:31], a[108:111], v[160:167], v11 abid:1
    v_smfmac_f32_16x16x64_bf16 v[32:35], a[108:111], v[168:175], v11
    v_smfmac_f32_16x16x64_bf16 v[36:39], a[108:111], v[168:175], v11 abid:1
    v_smfmac_f32_16x16x64_bf16 v[24:27], a[112:115], v[176:183], v11
    v_smfmac_f32_16x16x64_bf16 v[28:31], a[112:115], v[176:183], v11 abid:1
    v_smfmac_f32_16x16x64_bf16 v[32:35], a[112:115], v[184:191], v11
    v_smfmac_f32_16x16x64_bf16 v[36:39], a[112:115], v[184:191], v11 abid:1
    v_smfmac_f32_16x16x64_bf16 v[24:27], a[116:119], v[192:199], v11
    v_smfmac_f32_16x16x64_bf16 v[28:31], a[116:119], v[192:199], v11 abid:1
    v_smfmac_f32_16x16x64_bf16 v[32:35], a[116:119], v[200:207], v11
    v_smfmac_f32_16x16x64_bf16 v[36:39], a[116:119], v[200:207], v11 abid:1
    v_smfmac_f32_16x16x64_bf16 v[24:27], a[120:123], v[208:215], v11
    v_smfmac_f32_16x16x64_bf16 v[28:31], a[120:123], v[208:215], v11 abid:1
    v_smfmac_f32_16x16x64_bf16 v[32:35], a[120:123], v[216:223], v11
    v_smfmac_f32_16x16x64_bf16 v[36:39], a[120:123], v[216:223], v11 abid:1
    v_smfmac_f32_16x16x64_bf16 v[24:27], a[124:127], v[224:231], v11
    v_smfmac_f32_16x16x64_bf16 v[28:31], a[124:127], v[224:231], v11 abid:1
    v_smfmac_f32_16x16x64_bf16 v[32:35], a[124:127], v[232:239], v11
    v_smfmac_f32_16x16x64_bf16 v[36:39], a[124:127], v[232:239], v11 abid:1
    v_smfmac_f32_16x16x64_bf16 v[24:27], a[128:131], v[240:247], v11
    v_smfmac_f32_16x16x64_bf16 v[28:31], a[128:131], v[240:247], v11 abid:1
    v_smfmac_f32_16x16x64_bf16 v[32:35], a[128:131], v[248:255], v11
    v_smfmac_f32_16x16x64_bf16 v[36:39], a[128:131], v[248:255], v11 abid:1
    s_nop 7
    v_cmp_u_f32 vcc, v24, v25
    s_cbranch_vccnz G2_R2
    v_cmp_u_f32 vcc, v26, v27
    s_cbranch_vccnz G2_R2
    s_branch G2_C2
G2_R3:
    s_add_u32 s69, s69, 1
    s_cmp_gt_u32 s69, 20000
    s_cbranch_scc1 G2_C3
    s_mov_b32 s61, s60
    s_mov_b32 s60, 135168
    buffer_load_dwordx4 a[132:135], v130, s[44:47], s60 offen offset:0 sc1
    buffer_load_dwordx4 a[136:139], v130, s[44:47], s60 offen offset:1024 sc1
    buffer_load_dwordx4 a[140:143], v130, s[44:47], s60 offen offset:2048 sc1
    buffer_load_dwordx4 a[144:147], v130, s[44:47], s60 offen offset:3072 sc1
    s_mov_b32 s60, 139264
    buffer_load_dwordx4 a[148:151], v130, s[44:47], s60 offen offset:0 sc1
    buffer_load_dwordx4 a[152:155], v130, s[44:47], s60 offen offset:1024 sc1
    buffer_load_dwordx4 a[156:159], v130, s[44:47], s60 offen offset:2048 sc1
    buffer_load_dwordx4 a[160:163], v130, s[44:47], s60 offen offset:3072 sc1
    s_mov_b32 s60, 143360
    buffer_load_dwordx4 a[164:167], v130, s[44:47], s60 offen offset:0 sc1
    buffer_load_dwordx4 a[168:171], v130, s[44:47], s60 offen offset:1024 sc1
    s_add_u32 s60, s60, s78
    buffer_load_dwordx4 a[172:175], v130, s[44:47], s60 offen offset:2048 sc1
    s_mov_b32 s60, s61
    v_xor_b32 v140, 96, v137
    ds_read2_b32 v[96:97], v140 offset1:32
    s_waitcnt vmcnt(0) lgkmcnt(0)
    v_lshlrev_b32 v72, 16, v96
    v_and_b32 v73, 0xffff0000, v96
    v_lshlrev_b32 v76, 16, v97
    v_and_b32 v77, 0xffff0000, v97
    v_mov_b32 v74, 0
    v_mov_b32 v75, 0
    v_mov_b32 v78, 0
    v_mov_b32 v79, 0
    v_mov_b32 v80, 0
    v_mov_b32 v81, 0
    v_mov_b32 v82, 0
    v_mov_b32 v83, 0
    v_mov_b32 v84, 0
    v_mov_b32 v85, 0
    v_mov_b32 v86, 0
    v_mov_b32 v87, 0
    v_smfmac_f32_16x16x64_bf16 v[72:75], a[132:135], a[192:199], v11
    v_smfmac_f32_16x16x64_bf16 v[76:79], a[132:135], a[192:199], v11 abid:1
    v_smfmac_f32_16x16x64_bf16 v[80:83], a[132:135], a[200:207], v11
    v_smfmac_f32_16x16x64_bf16 v[84:87], a[132:135], a[200:207], v11 abid:1
    v_smfmac_f32_16x16x64_bf16 v[72:75], a[136:139], a[208:215], v11
    v_smfmac_f32_16x16x64_bf16 v[76:79], a[136:139], a[208:215], v11 abid:1
    v_smfmac_f32_16x16x64_bf16 v[80:83], a[136:139], a[216:223], v11
    v_smfmac_f32_16x16x64_bf16 v[84:87], a[136:139], a[216:223], v11 abid:1
    v_smfmac_f32_16x16x64_bf16 v[72:75], a[140:143], a[224:231], v11
    v_smfmac_f32_16x16x64_bf16 v[76:79], a[140:143], a[224:231], v11 abid:1
    v_smfmac_f32_16x16x64_bf16 v[80:83], a[140:143], a[232:239], v11
    v_smfmac_f32_16x16x64_bf16 v[84:87], a[140:143], a[232:239], v11 abid:1
    v_smfmac_f32_16x16x64_bf16 v[72:75], a[144:147], a[240:247], v11
    v_smfmac_f32_16x16x64_bf16 v[76:79], a[144:147], a[240:247], v11 abid:1
    v_smfmac_f32_16x16x64_bf16 v[80:83], a[144:147], a[248:255], v11
    v_smfmac_f32_16x16x64_bf16 v[84:87], a[144:147], a[248:255], v11 abid:1
    v_smfmac_f32_16x16x64_bf16 v[72:75], a[148:151], v[144:151], v11
    v_smfmac_f32_16x16x64_bf16 v[76:79], a[148:151], v[144:151], v11 abid:1
    v_smfmac_f32_16x16x64_bf16 v[80:83], a[148:151], v[152:159], v11
    v_smfmac_f32_16x16x64_bf16 v[84:87], a[148:151], v[152:159], v11 abid:1
    v_smfmac_f32_16x16x64_bf16 v[72:75], a[152:155], v[160:167], v11
    v_smfmac_f32_16x16x64_bf16 v[76:79], a[152:155], v[160:167], v11 abid:1
    v_smfmac_f32_16x16x64_bf16 v[80:83], a[152:155], v[168:175], v11
    v_smfmac_f32_16x16x64_bf16 v[84:87], a[152:155], v[168:175], v11 abid:1
    v_smfmac_f32_16x16x64_bf16 v[72:75], a[156:159], v[176:183], v11
    v_smfmac_f32_16x16x64_bf16 v[76:79], a[156:159], v[176:183], v11 abid:1
    v_smfmac_f32_16x16x64_bf16 v[80:83], a[156:159], v[184:191], v11
    v_smfmac_f32_16x16x64_bf16 v[84:87], a[156:159], v[184:191], v11 abid:1
    v_smfmac_f32_16x16x64_bf16 v[80:83], a[160:163], v[200:207], v11
    v_smfmac_f32_16x16x64_bf16 v[84:87], a[160:163], v[200:207], v11 abid:1
    v_smfmac_f32_16x16x64_bf16 v[80:83], a[164:167], v[216:223], v11
    v_smfmac_f32_16x16x64_bf16 v[84:87], a[164:167], v[216:223], v11 abid:1
    v_smfmac_f32_16x16x64_bf16 v[80:83], a[168:171], v[232:239], v11
    v_smfmac_f32_16x16x64_bf16 v[84:87], a[168:171], v[232:239], v11 abid:1
    v_smfmac_f32_16x16x64_bf16 v[80:83], a[172:175], v[248:255], v11
    v_smfmac_f32_16x16x64_bf16 v[84:87], a[172:175], v[248:255], v11 abid:1
    v_smfmac_f32_16x16x64_bf16 v[72:75], a[160:163], v[192:199], v11
    v_smfmac_f32_16x16x64_bf16 v[76:79], a[160:163], v[192:199], v11 abid:1
    v_smfmac_f32_16x16x64_bf16 v[72:75], a[164:167], v[208:215], v11
    v_smfmac_f32_16x16x64_bf16 v[76:79], a[164:167], v[208:215], v11 abid:1
    s_nop 7
    v_cmp_u_f32 vcc, v80, v81
    s_cbranch_vccnz G2_R3
    v_cmp_u_f32 vcc, v82, v83
    s_cbranch_vccnz G2_R3
    s_branch G2_C3
K_LAST:
    s_endpgm
.section .rodata,"a"
.p2align 6
.amdhsa_kernel sequential_preLN__ssm_conv_s4d__dense_activation_silu__prompt_kernel
  .amdhsa_next_free_vgpr 512
  .amdhsa_next_free_sgpr 102
  .amdhsa_accum_offset 256
  .amdhsa_group_segment_fixed_size 0
  .amdhsa_kernarg_size 104
  .amdhsa_user_sgpr_count 2
  .amdhsa_user_sgpr_kernarg_segment_ptr 1
  .amdhsa_system_sgpr_workgroup_id_x 1
.end_amdhsa_kernel
```
